```python
import torch

def _softmax(x, axis=-1):
    return torch.softmax(x, dim=axis)
def _gelu(x):
    return torch.nn.functional.gelu(x, approximate="tanh")
def _silu(x):
    return torch.nn.functional.silu(x)
def _sigmoid(x):
    return torch.sigmoid(x)
def _layernorm(x, axis=-1, eps=1e-5):
    m = x.mean(dim=axis, keepdim=True)
    v = x.var(dim=axis, keepdim=True, unbiased=False)
    return (x - m) / torch.sqrt(v + eps)
def _scatter_add(tgt, idx, src, axis=0):
    return tgt.clone().index_add_(axis, idx, src)
def _segment_sum(src, seg, n):
    out = torch.zeros((n,) + src.shape[1:], dtype=src.dtype)
    return out.index_add_(0, seg, src)
def _pad(x, pw):
    flat = tuple(v for pair in reversed(pw) for v in pair)
    return torch.nn.functional.pad(x, flat)

kernel_name = 'concat_heads__sliding_block__spectral_fnet__prompt'

def setup_inputs():

    _w = (lambda a: (lambda t: t.to(torch.bfloat16) if t.is_floating_point() else t)(torch.as_tensor(a)))
    def _A_setup():
        B, S, D = 1, 2048, 448
        return {
            "x": _w((lambda *s: torch.randn(*s, dtype=torch.bfloat16) * 0.2)(B, S, D)),
            "wqkv": _w((lambda *s: torch.randn(*s, dtype=torch.bfloat16) * 0.8)(D, 3 * D)),
            "wo": _w((lambda *s: torch.randn(*s, dtype=torch.bfloat16) * 0.2)(D, D)),
        }
    _A_in = _A_setup()

    def _B_setup():
        B, S, D = 1, 2048, 448
        ns = torch.arange(S)[:, None] * torch.arange(S)[None, :]
        nd = torch.arange(D)[:, None] * torch.arange(D)[None, :]
        Ws_re = torch.cos(-2.0 * torch.pi * ns / S).to(float)
        Ws_im = torch.sin(-2.0 * torch.pi * ns / S).to(float)
        Wd_re = torch.cos(-2.0 * torch.pi * nd / D).to(float)
        Wd_im = torch.sin(-2.0 * torch.pi * nd / D).to(float)
        return {
            "x": _w((lambda *s: torch.randn(*s, dtype=torch.bfloat16) * 0.05)(B, S, D)),
            "dft_seq_re": _w(Ws_re),
            "dft_seq_im": _w(Ws_im),
            "dft_hid_re": _w(Wd_re),
            "dft_hid_im": _w(Wd_im),
        }
    _B_in = _B_setup()

    return {
        "A_x": _A_in["x"],
        "A_wqkv": _A_in["wqkv"],
        "A_wo": _A_in["wo"],
        "B_x": _B_in["x"],
        "B_dft_seq_re": _B_in["dft_seq_re"],
        "B_dft_seq_im": _B_in["dft_seq_im"],
        "B_dft_hid_re": _B_in["dft_hid_re"],
        "B_dft_hid_im": _B_in["dft_hid_im"],
    }

def reference(A_x, A_wqkv, A_wo, B_x, B_dft_seq_re, B_dft_seq_im, B_dft_hid_re, B_dft_hid_im):
    def _A_ref(x, wqkv, wo):
        B, S, D = x.shape
        H = 16; Dh = D // H; W = 256
        qkv = (lambda x, *d: x.permute(*d))((x @ wqkv).reshape(B, S, 3, H, Dh), 2, 0, 3, 1, 4)
        q, k, v = qkv[0], qkv[1], qkv[2]
        scores = torch.einsum("bhqd,bhkd->bhqk", q, k) * (Dh ** -0.5)
        idx = torch.arange(S)
        mask = (idx[:, None] - idx[None, :] >= 0) & (idx[:, None] - idx[None, :] < W)
        scores = torch.where(mask[None, None], scores, -1e9)
        p = _softmax(scores, axis=-1)
        o = torch.einsum("bhqk,bhkd->bhqd", p, v)
        return (lambda x, *d: x.permute(*d))(o, 0, 2, 1, 3).reshape(B, S, D) @ wo

    def _B_ref(x, dft_seq_re, dft_seq_im, dft_hid_re, dft_hid_im):
        a = torch.einsum("bsd,ed->bse", x, dft_hid_re)
        b = torch.einsum("bsd,ed->bse", x, dft_hid_im)
        y = torch.einsum("ts,bse->bte", dft_seq_re, a) - torch.einsum("ts,bse->bte", dft_seq_im, b)
        return y

    a = _A_ref(A_x, A_wqkv, A_wo)
    b = _B_ref(B_x, B_dft_seq_re, B_dft_seq_im, B_dft_hid_re, B_dft_hid_im)
    return torch.concatenate([a, b], axis=-1)
```

```asm
; @launch grid=(256,1,1) block=(512,1,1) lds=163840
.amdgcn_target "amdgcn-amd-amdhsa--gfx950"
.text
.globl concat_heads__sliding_block__spectral_fnet__prompt_kernel
.p2align 8
.type concat_heads__sliding_block__spectral_fnet__prompt_kernel,@function
concat_heads__sliding_block__spectral_fnet__prompt_kernel:
  s_cmp_ge_u32 s2, 256
  s_cbranch_scc1 L_end_1
  s_load_dwordx16 s[4:19], s[0:1], 0
  s_load_dwordx4 s[20:23], s[0:1], 64
  s_load_dwordx2 s[24:25], s[0:1], 80
  v_lshrrev_b32 v4, 6, v0
  v_and_b32 v1, 63, v0
  v_readfirstlane_b32 s64, v4
  v_lshrrev_b32 v2, 4, v1
  v_and_b32 v3, 15, v1
  s_and_b32 s65, s2, 7
  s_lshr_b32 s66, s2, 3
  s_and_b32 s67, s64, 3
  v_mov_b32 v37, 0
  v_mov_b32 v39, 0
  s_cmp_lt_u32 s64, 4
  s_cbranch_scc1 L_compute_2
  v_lshrrev_b32 v5, 3, v1
  v_and_b32 v6, 7, v1
  v_lshlrev_b32 v7, 4, v1
  v_xor_b32 v8, v5, v6
  v_lshlrev_b32 v8, 4, v8
  s_mul_i32 s88, s67, 2048
  s_mul_i32 s90, s67, 3584
  s_mul_i32 s89, s67, 3072
  s_mul_i32 s91, s67, 4096
  v_lshrrev_b32 v9, 2, v5
  v_lshlrev_b32 v9, 3, v9
  v_and_b32 v10, 3, v5
  v_add_u32 v9, v9, v10
  s_lshr_b32 s70, s67, 1
  s_lshl_b32 s70, s70, 5
  s_and_b32 s71, s67, 1
  s_lshl_b32 s71, s71, 2
  s_add_u32 s70, s70, s71
  v_add_u32 v9, s70, v9
  v_mul_u32_u24 v9, 896, v9
  v_add_u32 v208, v9, v8
  v_add_u32 v209, 13312, v208
  s_mul_i32 s70, s67, 28
  s_add_u32 s71, s70, 0
  v_add_u32 v9, s71, v5
  v_and_b32 v10, 0x63, v9
  v_bfe_u32 v11, v9, 2, 2
  v_lshl_add_u32 v10, v11, 3, v10
  v_bfe_u32 v11, v9, 4, 1
  v_lshl_add_u32 v10, v11, 2, v10
  v_cmp_le_u32 vcc, 96, v9
  v_and_b32 v11, 7, v9
  v_xor_b32 v11, v11, v6
  v_cndmask_b32 v10, v10, v9, vcc
  v_mul_u32_u24 v10, 896, v10
  v_lshl_add_u32 v10, v11, 4, v10
  v_subrev_u32 v210, 0, v10
  s_add_u32 s71, s70, 8
  v_add_u32 v9, s71, v5
  v_and_b32 v10, 0x63, v9
  v_bfe_u32 v11, v9, 2, 2
  v_lshl_add_u32 v10, v11, 3, v10
  v_bfe_u32 v11, v9, 4, 1
  v_lshl_add_u32 v10, v11, 2, v10
  v_cmp_le_u32 vcc, 96, v9
  v_and_b32 v11, 7, v9
  v_xor_b32 v11, v11, v6
  v_cndmask_b32 v10, v10, v9, vcc
  v_mul_u32_u24 v10, 896, v10
  v_lshl_add_u32 v10, v11, 4, v10
  v_subrev_u32 v211, 1024, v10
  s_add_u32 s71, s70, 16
  v_add_u32 v9, s71, v5
  v_and_b32 v10, 0x63, v9
  v_bfe_u32 v11, v9, 2, 2
  v_lshl_add_u32 v10, v11, 3, v10
  v_bfe_u32 v11, v9, 4, 1
  v_lshl_add_u32 v10, v11, 2, v10
  v_cmp_le_u32 vcc, 96, v9
  v_and_b32 v11, 7, v9
  v_xor_b32 v11, v11, v6
  v_cndmask_b32 v10, v10, v9, vcc
  v_mul_u32_u24 v10, 896, v10
  v_lshl_add_u32 v10, v11, 4, v10
  v_subrev_u32 v212, 2048, v10
  s_add_u32 s71, s70, 24
  v_add_u32 v9, s71, v5
  v_and_b32 v10, 0x63, v9
  v_bfe_u32 v11, v9, 2, 2
  v_lshl_add_u32 v10, v11, 3, v10
  v_bfe_u32 v11, v9, 4, 1
  v_lshl_add_u32 v10, v11, 2, v10
  v_cmp_le_u32 vcc, 96, v9
  v_and_b32 v11, 7, v9
  v_xor_b32 v11, v11, v6
  v_cndmask_b32 v10, v10, v9, vcc
  v_mul_u32_u24 v10, 896, v10
  v_lshl_add_u32 v10, v11, 4, v10
  v_subrev_u32 v213, 3072, v10
  s_and_b32 s70, s65, 3
  s_lshl_b32 s70, s70, 3
  s_and_b32 s71, s66, 7
  s_add_u32 s70, s70, s71
  s_mul_i32 s76, s70, 57344
  s_lshr_b32 s70, s66, 3
  s_mul_i32 s77, s70, 100352
  s_lshl_b32 s70, s70, 1
  s_add_u32 s70, s70, s71
  s_cmp_ge_u32 s70, 7
  s_cselect_b32 s93, 7, 0
  s_sub_u32 s93, s70, s93
  s_waitcnt lgkmcnt(0)
  s_mov_b32 s40, s10
  s_and_b32 s41, s11, 0xffff
  s_mov_b32 s42, 1835008
  s_mov_b32 s43, 0x20000
  s_add_u32 m0, s88, 0
  s_cmp_ge_u32 s93, 7
  s_cselect_b32 s70, -7, 0
  s_add_u32 s70, s70, s93
  s_mul_i32 s70, s70, 128
  s_add_u32 s70, s70, s76
  buffer_load_dwordx4 v208, s[40:43], s70 offen lds
  buffer_load_dwordx4 v209, s[40:43], s70 offen offset:1024 lds
  s_cmp_ge_u32 s65, 4
  s_cselect_b32 s48, s18, s16
  s_cselect_b32 s49, s19, s17
  s_and_b32 s49, s49, 0xffff
  s_mov_b32 s50, 401408
  s_mov_b32 s51, 0x20000
  s_add_u32 m0, s90, 16384
  s_cmp_ge_u32 s93, 7
  s_cselect_b32 s70, -7, 0
  s_add_u32 s70, s70, s93
  s_mul_i32 s70, s70, 128
  s_add_u32 s70, s70, s77
  buffer_load_dwordx4 v210, s[48:51], s70 offen lds
  buffer_load_dwordx4 v211, s[48:51], s70 offen offset:1024 lds
  buffer_load_dwordx4 v212, s[48:51], s70 offen offset:2048 lds
  s_mov_b32 exec_hi, 0
  buffer_load_dwordx4 v213, s[48:51], s70 offen offset:3072 lds
  s_mov_b32 exec_hi, -1
  s_add_u32 m0, s88, 32768
  s_cmp_ge_u32 s93, 6
  s_cselect_b32 s70, -6, 1
  s_add_u32 s70, s70, s93
  s_mul_i32 s70, s70, 128
  s_add_u32 s70, s70, s76
  buffer_load_dwordx4 v208, s[40:43], s70 offen lds
  buffer_load_dwordx4 v209, s[40:43], s70 offen offset:1024 lds
  s_add_u32 m0, s90, 49152
  s_cmp_ge_u32 s93, 6
  s_cselect_b32 s70, -6, 1
  s_add_u32 s70, s70, s93
  s_mul_i32 s70, s70, 128
  s_add_u32 s70, s70, s77
  buffer_load_dwordx4 v210, s[48:51], s70 offen lds
  buffer_load_dwordx4 v211, s[48:51], s70 offen offset:1024 lds
  buffer_load_dwordx4 v212, s[48:51], s70 offen offset:2048 lds
  s_mov_b32 exec_hi, 0
  buffer_load_dwordx4 v213, s[48:51], s70 offen offset:3072 lds
  s_mov_b32 exec_hi, -1
  s_add_u32 m0, s88, 65536
  s_cmp_ge_u32 s93, 5
  s_cselect_b32 s70, -5, 2
  s_add_u32 s70, s70, s93
  s_mul_i32 s70, s70, 128
  s_add_u32 s70, s70, s76
  buffer_load_dwordx4 v208, s[40:43], s70 offen lds
  buffer_load_dwordx4 v209, s[40:43], s70 offen offset:1024 lds
  s_add_u32 m0, s90, 81920
  s_cmp_ge_u32 s93, 5
  s_cselect_b32 s70, -5, 2
  s_add_u32 s70, s70, s93
  s_mul_i32 s70, s70, 128
  s_add_u32 s70, s70, s77
  buffer_load_dwordx4 v210, s[48:51], s70 offen lds
  buffer_load_dwordx4 v211, s[48:51], s70 offen offset:1024 lds
  buffer_load_dwordx4 v212, s[48:51], s70 offen offset:2048 lds
  s_mov_b32 exec_hi, 0
  buffer_load_dwordx4 v213, s[48:51], s70 offen offset:3072 lds
  s_mov_b32 exec_hi, -1
  s_lshl_b32 s70, s67, 5
  v_add_u32 v9, s70, v5
  v_mul_u32_u24 v9, 896, v9
  v_add_u32 v214, v9, v8
  v_add_u32 v215, 6144, v214
  v_add_u32 v216, 12288, v214
  v_add_u32 v217, 18432, v214
  s_lshl_b32 s70, s67, 4
  v_add_u32 v9, 0, v1
  v_mul_u32_u24 v10, 0x5556, v9
  v_lshrrev_b32 v10, 18, v10
  v_mul_u32_u24 v11, 12, v10
  v_sub_u32 v11, v9, v11
  v_and_b32 v12, 8, v10
  v_add_u32 v10, s70, v10
  v_mul_u32_u24 v10, 2688, v10
  v_lshl_add_u32 v10, v11, 4, v10
  v_sub_u32 v10, v10, v12
  v_subrev_u32 v218, 0, v10
  v_cmp_eq_u32 vcc, 11, v11
  v_mov_b32 v12, 0x7fffffff
  s_nop 0
  v_cndmask_b32 v218, v218, v12, vcc
  v_add_u32 v9, 64, v1
  v_mul_u32_u24 v10, 0x5556, v9
  v_lshrrev_b32 v10, 18, v10
  v_mul_u32_u24 v11, 12, v10
  v_sub_u32 v11, v9, v11
  v_and_b32 v12, 8, v10
  v_add_u32 v10, s70, v10
  v_mul_u32_u24 v10, 2688, v10
  v_lshl_add_u32 v10, v11, 4, v10
  v_sub_u32 v10, v10, v12
  v_subrev_u32 v219, 1024, v10
  v_cmp_eq_u32 vcc, 11, v11
  v_mov_b32 v12, 0x7fffffff
  s_nop 0
  v_cndmask_b32 v219, v219, v12, vcc
  v_add_u32 v9, 128, v1
  v_mul_u32_u24 v10, 0x5556, v9
  v_lshrrev_b32 v10, 18, v10
  v_mul_u32_u24 v11, 12, v10
  v_sub_u32 v11, v9, v11
  v_and_b32 v12, 8, v10
  v_add_u32 v10, s70, v10
  v_mul_u32_u24 v10, 2688, v10
  v_lshl_add_u32 v10, v11, 4, v10
  v_sub_u32 v10, v10, v12
  v_subrev_u32 v220, 2048, v10
  v_cmp_eq_u32 vcc, 11, v11
  v_mov_b32 v12, 0x7fffffff
  s_nop 0
  v_cndmask_b32 v220, v220, v12, vcc
  s_lshr_b32 s70, s65, 1
  s_lshl_b32 s70, s70, 2
  s_and_b32 s71, s66, 3
  s_add_u32 s70, s70, s71
  s_mul_i32 s78, s70, 114688
  s_and_b32 s70, s65, 1
  s_lshl_b32 s70, s70, 3
  s_lshr_b32 s72, s66, 2
  s_add_u32 s70, s70, s72
  s_mul_i32 s79, s70, 168
  s_lshl_b32 s71, s71, 1
  s_add_u32 s70, s71, s72
  s_cmp_ge_u32 s70, 7
  s_cselect_b32 s94, 7, 0
  s_sub_u32 s94, s70, s94
  s_waitcnt vmcnt(12)
  s_barrier
  s_add_u32 m0, s88, 98304
  s_cmp_ge_u32 s93, 4
  s_cselect_b32 s70, -4, 3
  s_add_u32 s70, s70, s93
  s_mul_i32 s70, s70, 128
  s_add_u32 s70, s70, s76
  buffer_load_dwordx4 v208, s[40:43], s70 offen lds
  buffer_load_dwordx4 v209, s[40:43], s70 offen offset:1024 lds
  s_add_u32 m0, s90, 114688
  s_cmp_ge_u32 s93, 4
  s_cselect_b32 s70, -4, 3
  s_add_u32 s70, s70, s93
  s_mul_i32 s70, s70, 128
  s_add_u32 s70, s70, s77
  buffer_load_dwordx4 v210, s[48:51], s70 offen lds
  buffer_load_dwordx4 v211, s[48:51], s70 offen offset:1024 lds
  buffer_load_dwordx4 v212, s[48:51], s70 offen offset:2048 lds
  s_mov_b32 exec_hi, 0
  buffer_load_dwordx4 v213, s[48:51], s70 offen offset:3072 lds
  s_mov_b32 exec_hi, -1
  s_add_u32 m0, s88, 131072
  s_cmp_ge_u32 s93, 3
  s_cselect_b32 s70, -3, 4
  s_add_u32 s70, s70, s93
  s_mul_i32 s70, s70, 128
  s_add_u32 s70, s70, s76
  buffer_load_dwordx4 v208, s[40:43], s70 offen lds
  buffer_load_dwordx4 v209, s[40:43], s70 offen offset:1024 lds
  s_add_u32 m0, s90, 147456
  s_cmp_ge_u32 s93, 3
  s_cselect_b32 s70, -3, 4
  s_add_u32 s70, s70, s93
  s_mul_i32 s70, s70, 128
  s_add_u32 s70, s70, s77
  buffer_load_dwordx4 v210, s[48:51], s70 offen lds
  buffer_load_dwordx4 v211, s[48:51], s70 offen offset:1024 lds
  buffer_load_dwordx4 v212, s[48:51], s70 offen offset:2048 lds
  s_mov_b32 exec_hi, 0
  buffer_load_dwordx4 v213, s[48:51], s70 offen offset:3072 lds
  s_mov_b32 exec_hi, -1
  s_lshl_b32 s70, s67, 5
  v_add_u32 v9, s70, v5
  v_lshlrev_b32 v9, 12, v9
  v_add_u32 v221, v9, v8
  v_add_u32 v222, 31744, v221
  v_add_u32 v223, 63488, v221
  v_add_u32 v224, 95232, v221
  v_add_u32 v230, s90, v7
  s_and_b32 s70, s65, 1
  s_lshl_b32 s70, s70, 3
  s_lshr_b32 s72, s66, 2
  s_add_u32 s70, s70, s72
  s_and_b32 s71, s66, 3
  s_mul_i32 s75, s71, 2
  s_mul_i32 s95, s71, 1
  s_lshl_b32 s92, s70, 1
  s_lshl_b32 s80, s70, 19
  s_bfe_u32 s72, s65, 0x10001
  s_lshl_b32 s72, s72, 11
  s_add_u32 s80, s80, s72
  s_lshr_b32 s72, s65, 1
  s_mul_i32 s81, s72, 917504
  s_mul_i32 s71, s71, 14336
  s_add_u32 s81, s81, s71
  s_waitcnt vmcnt(18)
  s_barrier
  s_add_u32 m0, s88, 0
  s_cmp_ge_u32 s93, 2
  s_cselect_b32 s70, -2, 5
  s_add_u32 s70, s70, s93
  s_mul_i32 s70, s70, 128
  s_add_u32 s70, s70, s76
  buffer_load_dwordx4 v208, s[40:43], s70 offen lds
  buffer_load_dwordx4 v209, s[40:43], s70 offen offset:1024 lds
  s_add_u32 m0, s90, 16384
  s_cmp_ge_u32 s93, 2
  s_cselect_b32 s70, -2, 5
  s_add_u32 s70, s70, s93
  s_mul_i32 s70, s70, 128
  s_add_u32 s70, s70, s77
  buffer_load_dwordx4 v210, s[48:51], s70 offen lds
  buffer_load_dwordx4 v211, s[48:51], s70 offen offset:1024 lds
  buffer_load_dwordx4 v212, s[48:51], s70 offen offset:2048 lds
  s_mov_b32 exec_hi, 0
  buffer_load_dwordx4 v213, s[48:51], s70 offen offset:3072 lds
  s_mov_b32 exec_hi, -1
  v_add_u32 v229, s88, v7
  s_lshl_b32 s70, s65, 1
  s_and_b32 s71, s66, 1
  s_add_u32 s70, s70, s71
  s_lshl_b32 s70, s70, 17
  s_add_u32 s70, s70, 4194304
  s_lshr_b32 s71, s66, 1
  s_lshl_b32 s72, s71, 13
  s_add_u32 s85, s70, s72
  s_add_u32 s70, s70, 2097152
  s_add_i32 s72, s71, -2
  s_max_i32 s72, s72, 0
  s_lshl_b32 s72, s72, 13
  s_add_u32 s82, s70, s72
  s_add_i32 s72, s71, -1
  s_max_i32 s72, s72, 0
  s_lshl_b32 s72, s72, 13
  s_add_u32 s83, s70, s72
  s_add_i32 s72, s71, 0
  s_max_i32 s72, s72, 0
  s_lshl_b32 s72, s72, 13
  s_add_u32 s84, s70, s72
  v_mov_b32 v204, 0
  v_mov_b32 v205, 0
  v_mov_b32 v207, 0
  v_mov_b32 v9, 0xff7f
  v_cmp_eq_u32 vcc, 3, v2
  s_nop 1
  v_cndmask_b32 v206, v204, v9, vcc
  v_add_u32 v232, 65536, v229
  s_waitcnt vmcnt(18)
  s_barrier
  s_add_u32 m0, s88, 32768
  s_cmp_ge_u32 s93, 1
  s_cselect_b32 s70, -1, 6
  s_add_u32 s70, s70, s93
  s_mul_i32 s70, s70, 128
  s_add_u32 s70, s70, s76
  buffer_load_dwordx4 v208, s[40:43], s70 offen lds
  buffer_load_dwordx4 v209, s[40:43], s70 offen offset:1024 lds
  s_add_u32 m0, s90, 49152
  s_cmp_ge_u32 s93, 1
  s_cselect_b32 s70, -1, 6
  s_add_u32 s70, s70, s93
  s_mul_i32 s70, s70, 128
  s_add_u32 s70, s70, s77
  buffer_load_dwordx4 v210, s[48:51], s70 offen lds
  buffer_load_dwordx4 v211, s[48:51], s70 offen offset:1024 lds
  buffer_load_dwordx4 v212, s[48:51], s70 offen offset:2048 lds
  s_mov_b32 exec_hi, 0
  buffer_load_dwordx4 v213, s[48:51], s70 offen offset:3072 lds
  s_mov_b32 exec_hi, -1
  s_mul_i32 s70, s67, 28
  v_add_u32 v9, s70, v5
  v_mul_u32_u24 v9, 896, v9
  v_and_b32 v10, 6, v5
  v_xor_b32 v10, v10, v6
  v_lshl_add_u32 v225, v10, 4, v9
  v_add_u32 v226, 6144, v225
  v_add_u32 v227, 12288, v225
  v_add_u32 v228, 18432, v225
  s_lshr_b32 s70, s66, 2
  s_min_u32 s70, s70, 6
  s_lshl_b32 s86, s70, 7
  s_cmp_ge_u32 s66, 28
  s_cselect_b32 s86, 0x40000000, s86
  s_waitcnt vmcnt(18)
  s_barrier
  s_mov_b32 s28, s4
  s_and_b32 s29, s5, 0xffff
  s_mov_b32 s30, 1835008
  s_mov_b32 s31, 0x20000
  s_add_u32 m0, s91, 65536
  s_cmp_ge_u32 s94, 7
  s_cselect_b32 s70, -7, 0
  s_add_u32 s70, s70, s94
  s_mul_i32 s70, s70, 128
  s_add_u32 s70, s70, s78
  buffer_load_dwordx4 v214, s[28:31], s70 offen lds
  buffer_load_dwordx4 v215, s[28:31], s70 offen offset:1024 lds
  buffer_load_dwordx4 v216, s[28:31], s70 offen offset:2048 lds
  buffer_load_dwordx4 v217, s[28:31], s70 offen offset:3072 lds
  s_mov_b32 s32, s6
  s_and_b32 s33, s7, 0xffff
  s_mov_b32 s34, 1204224
  s_mov_b32 s35, 0x20000
  s_add_u32 m0, s89, 81920
  s_cmp_ge_u32 s94, 7
  s_cselect_b32 s70, -7, 0
  s_add_u32 s70, s70, s94
  s_mul_i32 s70, s70, 172032
  s_add_u32 s70, s70, s79
  buffer_load_dwordx4 v218, s[32:35], s70 offen lds
  buffer_load_dwordx4 v219, s[32:35], s70 offen offset:1024 lds
  buffer_load_dwordx4 v220, s[32:35], s70 offen offset:2048 lds
  s_lshl_b32 s70, s67, 14
  v_add_u32 v231, s70, v7
  s_and_b32 s70, s66, 3
  s_lshl_b32 s71, s65, 2
  s_add_u32 s70, s70, s71
  s_lshl_b32 s70, s70, 16
  s_add_u32 s87, s70, 10485760
  s_cmp_ge_u32 s66, 28
  s_cselect_b32 s87, 0x40000000, s87
  s_lshl_b32 s26, s2, 5
  s_add_u32 s26, s26, s64
  s_lshl_b32 s26, s26, 2
  s_add_u32 s26, s26, 20971520
  s_cmp_ge_u32 s65, 4
  s_cselect_b32 s44, s14, s12
  s_cselect_b32 s45, s15, s13
  s_and_b32 s45, s45, 0xffff
  s_mov_b32 s46, 8388608
  s_mov_b32 s47, 0x20000
  s_mov_b32 s36, s8
  s_and_b32 s37, s9, 0xffff
  s_mov_b32 s38, 401408
  s_mov_b32 s39, 0x20000
  s_mov_b32 s52, s24
  s_and_b32 s53, s25, 0xffff
  s_mov_b32 s54, 268435456
  s_mov_b32 s55, 0x20000
  s_mov_b32 s56, s20
  s_and_b32 s57, s21, 0xffff
  s_mov_b32 s58, 3670016
  s_mov_b32 s59, 0x20000
  s_mov_b32 s60, s22
  s_and_b32 s61, s23, 0xffff
  s_mov_b32 s62, 256
  s_mov_b32 s63, 0x20000
  buffer_load_dword v233, v37, s[60:63], 0 offen sc1
  s_waitcnt vmcnt(20)
  s_barrier
  s_waitcnt vmcnt(14)
  s_barrier
  s_waitcnt vmcnt(8)
  s_barrier
  s_barrier
  s_add_u32 m0, s91, 98304
  s_cmp_ge_u32 s94, 6
  s_cselect_b32 s70, -6, 1
  s_add_u32 s70, s70, s94
  s_mul_i32 s70, s70, 128
  s_add_u32 s70, s70, s78
  buffer_load_dwordx4 v214, s[28:31], s70 offen lds
  buffer_load_dwordx4 v215, s[28:31], s70 offen offset:1024 lds
  buffer_load_dwordx4 v216, s[28:31], s70 offen offset:2048 lds
  buffer_load_dwordx4 v217, s[28:31], s70 offen offset:3072 lds
  s_add_u32 m0, s89, 114688
  s_cmp_ge_u32 s94, 6
  s_cselect_b32 s70, -6, 1
  s_add_u32 s70, s70, s94
  s_mul_i32 s70, s70, 172032
  s_add_u32 s70, s70, s79
  buffer_load_dwordx4 v218, s[32:35], s70 offen lds
  buffer_load_dwordx4 v219, s[32:35], s70 offen offset:1024 lds
  buffer_load_dwordx4 v220, s[32:35], s70 offen offset:2048 lds
  s_waitcnt vmcnt(8)
  s_barrier
  s_add_u32 m0, s91, 131072
  s_cmp_ge_u32 s94, 5
  s_cselect_b32 s70, -5, 2
  s_add_u32 s70, s70, s94
  s_mul_i32 s70, s70, 128
  s_add_u32 s70, s70, s78
  buffer_load_dwordx4 v214, s[28:31], s70 offen lds
  buffer_load_dwordx4 v215, s[28:31], s70 offen offset:1024 lds
  buffer_load_dwordx4 v216, s[28:31], s70 offen offset:2048 lds
  buffer_load_dwordx4 v217, s[28:31], s70 offen offset:3072 lds
  s_add_u32 m0, s89, 147456
  s_cmp_ge_u32 s94, 5
  s_cselect_b32 s70, -5, 2
  s_add_u32 s70, s70, s94
  s_mul_i32 s70, s70, 172032
  s_add_u32 s70, s70, s79
  buffer_load_dwordx4 v218, s[32:35], s70 offen lds
  buffer_load_dwordx4 v219, s[32:35], s70 offen offset:1024 lds
  buffer_load_dwordx4 v220, s[32:35], s70 offen offset:2048 lds
  s_add_u32 m0, s91, 0
  s_cmp_ge_u32 s94, 4
  s_cselect_b32 s70, -4, 3
  s_add_u32 s70, s70, s94
  s_mul_i32 s70, s70, 128
  s_add_u32 s70, s70, s78
  buffer_load_dwordx4 v214, s[28:31], s70 offen lds
  buffer_load_dwordx4 v215, s[28:31], s70 offen offset:1024 lds
  buffer_load_dwordx4 v216, s[28:31], s70 offen offset:2048 lds
  buffer_load_dwordx4 v217, s[28:31], s70 offen offset:3072 lds
  s_add_u32 m0, s89, 16384
  s_cmp_ge_u32 s94, 4
  s_cselect_b32 s70, -4, 3
  s_add_u32 s70, s70, s94
  s_mul_i32 s70, s70, 172032
  s_add_u32 s70, s70, s79
  buffer_load_dwordx4 v218, s[32:35], s70 offen lds
  buffer_load_dwordx4 v219, s[32:35], s70 offen offset:1024 lds
  buffer_load_dwordx4 v220, s[32:35], s70 offen offset:2048 lds
  s_waitcnt vmcnt(14)
  s_barrier
  s_add_u32 m0, s91, 32768
  s_cmp_ge_u32 s94, 3
  s_cselect_b32 s70, -3, 4
  s_add_u32 s70, s70, s94
  s_mul_i32 s70, s70, 128
  s_add_u32 s70, s70, s78
  buffer_load_dwordx4 v214, s[28:31], s70 offen lds
  buffer_load_dwordx4 v215, s[28:31], s70 offen offset:1024 lds
  buffer_load_dwordx4 v216, s[28:31], s70 offen offset:2048 lds
  buffer_load_dwordx4 v217, s[28:31], s70 offen offset:3072 lds
  s_add_u32 m0, s89, 49152
  s_cmp_ge_u32 s94, 3
  s_cselect_b32 s70, -3, 4
  s_add_u32 s70, s70, s94
  s_mul_i32 s70, s70, 172032
  s_add_u32 s70, s70, s79
  buffer_load_dwordx4 v218, s[32:35], s70 offen lds
  buffer_load_dwordx4 v219, s[32:35], s70 offen offset:1024 lds
  buffer_load_dwordx4 v220, s[32:35], s70 offen offset:2048 lds
  s_add_u32 m0, s91, 65536
  s_cmp_ge_u32 s94, 2
  s_cselect_b32 s70, -2, 5
  s_add_u32 s70, s70, s94
  s_mul_i32 s70, s70, 128
  s_add_u32 s70, s70, s78
  buffer_load_dwordx4 v214, s[28:31], s70 offen lds
  buffer_load_dwordx4 v215, s[28:31], s70 offen offset:1024 lds
  buffer_load_dwordx4 v216, s[28:31], s70 offen offset:2048 lds
  buffer_load_dwordx4 v217, s[28:31], s70 offen offset:3072 lds
  s_add_u32 m0, s89, 81920
  s_cmp_ge_u32 s94, 2
  s_cselect_b32 s70, -2, 5
  s_add_u32 s70, s70, s94
  s_mul_i32 s70, s70, 172032
  s_add_u32 s70, s70, s79
  buffer_load_dwordx4 v218, s[32:35], s70 offen lds
  buffer_load_dwordx4 v219, s[32:35], s70 offen offset:1024 lds
  buffer_load_dwordx4 v220, s[32:35], s70 offen offset:2048 lds
  v_cmp_eq_u32 vcc, 0, v233
  s_nop 1
  s_cbranch_vccz L_nok_3
  buffer_load_dword v233, v37, s[60:63], 0 offen sc1
  s_mov_b32 s69, 0
L_sp_4:
  s_waitcnt vmcnt(0)
  v_cmp_eq_u32 vcc, 0, v233
  s_nop 1
  s_cbranch_vccz L_ok_5
  s_mov_b64 exec, vcc
  s_add_u32 s69, s69, 1
  s_cmp_ge_u32 s69, 0x40000
  s_cbranch_scc1 L_ok_5
  s_sleep 1
  buffer_load_dword v233, v37, s[60:63], 0 offen sc1
  s_branch L_sp_4
L_ok_5:
  s_mov_b64 exec, -1
L_nok_3:
  v_readfirstlane_b32 s68, v233
  s_and_b32 s70, s66, 3
  s_lshl_b32 s70, s70, 9
  s_and_b32 s71, s65, 6
  s_lshl_b32 s71, s71, 3
  s_add_u32 s70, s70, s71
  v_bfe_u32 v4, v1, 2, 3
  v_and_b32 v39, 3, v1
  v_lshl_add_u32 v39, v4, 6, v39
  v_lshrrev_b32 v4, 5, v1
  v_lshl_add_u32 v39, v4, 3, v39
  v_add_u32 v39, s70, v39
  v_and_b32 v4, 7, v39
  v_lshrrev_b32 v39, 3, v39
  v_lshlrev_b32 v39, 7, v39
  v_lshl_add_u32 v39, v4, 2, v39
  v_add_u32 v39, 20971520, v39
  s_waitcnt vmcnt(21)
  s_barrier
  buffer_load_dword v38, v39, s[52:55], 0 offen sc1
  s_add_u32 m0, s91, 98304
  s_cmp_ge_u32 s94, 1
  s_cselect_b32 s70, -1, 6
  s_add_u32 s70, s70, s94
  s_mul_i32 s70, s70, 128
  s_add_u32 s70, s70, s78
  buffer_load_dwordx4 v214, s[28:31], s70 offen lds
  buffer_load_dwordx4 v215, s[28:31], s70 offen offset:1024 lds
  buffer_load_dwordx4 v216, s[28:31], s70 offen offset:2048 lds
  buffer_load_dwordx4 v217, s[28:31], s70 offen offset:3072 lds
  s_add_u32 m0, s89, 114688
  s_cmp_ge_u32 s94, 1
  s_cselect_b32 s70, -1, 6
  s_add_u32 s70, s70, s94
  s_mul_i32 s70, s70, 172032
  s_add_u32 s70, s70, s79
  buffer_load_dwordx4 v218, s[32:35], s70 offen lds
  buffer_load_dwordx4 v219, s[32:35], s70 offen offset:1024 lds
  buffer_load_dwordx4 v220, s[32:35], s70 offen offset:2048 lds
  s_waitcnt vmcnt(22)
  s_barrier
  s_waitcnt vmcnt(7)
  v_cmp_ne_u32 vcc, s68, v38
  s_nop 1
  s_cbranch_vccz L_fast_6
  s_mov_b32 s69, 0
L_sp_7:
  s_waitcnt vmcnt(0)
  v_cmp_ne_u32 vcc, s68, v38
  s_nop 1
  s_cbranch_vccz L_ok_8
  s_mov_b64 exec, vcc
  s_add_u32 s69, s69, 1
  s_cmp_ge_u32 s69, 0x40000
  s_cbranch_scc1 L_ok_8
  s_sleep 1
  buffer_load_dword v38, v39, s[52:55], 0 offen sc1
  s_branch L_sp_7
L_ok_8:
  s_mov_b64 exec, -1
L_fast_6:
  s_add_u32 m0, s90, 131072
  s_xor_b32 s70, s95, 0
  s_add_u32 s70, s70, s92
  s_and_b32 s70, s70, 15
  s_mul_i32 s70, s70, 57344
  s_add_u32 s70, s70, s81
  buffer_load_dwordx4 v230, s[52:55], s70 offen sc1 lds
  buffer_load_dwordx4 v230, s[52:55], s70 offen offset:1024 sc1 lds
  buffer_load_dwordx4 v230, s[52:55], s70 offen offset:2048 sc1 lds
  s_mov_b32 exec_hi, 0
  buffer_load_dwordx4 v230, s[52:55], s70 offen offset:3072 sc1 lds
  s_mov_b32 exec_hi, -1
  s_add_u32 m0, s90, 147456
  s_xor_b32 s70, s95, 1
  s_add_u32 s70, s70, s92
  s_and_b32 s70, s70, 15
  s_mul_i32 s70, s70, 57344
  s_add_u32 s70, s70, s81
  buffer_load_dwordx4 v230, s[52:55], s70 offen sc1 lds
  buffer_load_dwordx4 v230, s[52:55], s70 offen offset:1024 sc1 lds
  buffer_load_dwordx4 v230, s[52:55], s70 offen offset:2048 sc1 lds
  s_mov_b32 exec_hi, 0
  buffer_load_dwordx4 v230, s[52:55], s70 offen offset:3072 sc1 lds
  s_mov_b32 exec_hi, -1
  s_barrier
  s_add_u32 m0, s91, 0
  s_xor_b32 s70, s95, 0
  s_add_u32 s70, s70, s92
  s_and_b32 s70, s70, 15
  s_mul_i32 s70, s70, 128
  s_add_u32 s70, s70, s80
  buffer_load_dwordx4 v221, s[44:47], s70 offen lds
  buffer_load_dwordx4 v222, s[44:47], s70 offen offset:1024 lds
  buffer_load_dwordx4 v223, s[44:47], s70 offen offset:2048 lds
  buffer_load_dwordx4 v224, s[44:47], s70 offen offset:3072 lds
  s_add_u32 m0, s91, 16384
  s_xor_b32 s70, s95, 1
  s_add_u32 s70, s70, s92
  s_and_b32 s70, s70, 15
  s_mul_i32 s70, s70, 128
  s_add_u32 s70, s70, s80
  buffer_load_dwordx4 v221, s[44:47], s70 offen lds
  buffer_load_dwordx4 v222, s[44:47], s70 offen offset:1024 lds
  buffer_load_dwordx4 v223, s[44:47], s70 offen offset:2048 lds
  buffer_load_dwordx4 v224, s[44:47], s70 offen offset:3072 lds
  s_barrier
  s_add_u32 m0, s91, 32768
  s_xor_b32 s70, s95, 2
  s_add_u32 s70, s70, s92
  s_and_b32 s70, s70, 15
  s_mul_i32 s70, s70, 128
  s_add_u32 s70, s70, s80
  buffer_load_dwordx4 v221, s[44:47], s70 offen lds
  buffer_load_dwordx4 v222, s[44:47], s70 offen offset:1024 lds
  buffer_load_dwordx4 v223, s[44:47], s70 offen offset:2048 lds
  buffer_load_dwordx4 v224, s[44:47], s70 offen offset:3072 lds
  s_add_u32 m0, s90, 49152
  s_xor_b32 s70, s95, 2
  s_add_u32 s70, s70, s92
  s_and_b32 s70, s70, 15
  s_mul_i32 s70, s70, 57344
  s_add_u32 s70, s70, s81
  buffer_load_dwordx4 v230, s[52:55], s70 offen sc1 lds
  buffer_load_dwordx4 v230, s[52:55], s70 offen offset:1024 sc1 lds
  buffer_load_dwordx4 v230, s[52:55], s70 offen offset:2048 sc1 lds
  s_mov_b32 exec_hi, 0
  buffer_load_dwordx4 v230, s[52:55], s70 offen offset:3072 sc1 lds
  s_mov_b32 exec_hi, -1
  s_waitcnt vmcnt(24)
  s_barrier
  s_add_u32 m0, s91, 65536
  s_xor_b32 s70, s95, 3
  s_add_u32 s70, s70, s92
  s_and_b32 s70, s70, 15
  s_mul_i32 s70, s70, 128
  s_add_u32 s70, s70, s80
  buffer_load_dwordx4 v221, s[44:47], s70 offen lds
  buffer_load_dwordx4 v222, s[44:47], s70 offen offset:1024 lds
  buffer_load_dwordx4 v223, s[44:47], s70 offen offset:2048 lds
  buffer_load_dwordx4 v224, s[44:47], s70 offen offset:3072 lds
  s_add_u32 m0, s90, 81920
  s_xor_b32 s70, s95, 3
  s_add_u32 s70, s70, s92
  s_and_b32 s70, s70, 15
  s_mul_i32 s70, s70, 57344
  s_add_u32 s70, s70, s81
  buffer_load_dwordx4 v230, s[52:55], s70 offen sc1 lds
  buffer_load_dwordx4 v230, s[52:55], s70 offen offset:1024 sc1 lds
  buffer_load_dwordx4 v230, s[52:55], s70 offen offset:2048 sc1 lds
  s_mov_b32 exec_hi, 0
  buffer_load_dwordx4 v230, s[52:55], s70 offen offset:3072 sc1 lds
  s_mov_b32 exec_hi, -1
  s_barrier
  s_waitcnt vmcnt(20)
  s_barrier
  s_add_u32 m0, s91, 98304
  s_xor_b32 s70, s95, 4
  s_add_u32 s70, s70, s92
  s_and_b32 s70, s70, 15
  s_mul_i32 s70, s70, 128
  s_add_u32 s70, s70, s80
  buffer_load_dwordx4 v221, s[44:47], s70 offen lds
  buffer_load_dwordx4 v222, s[44:47], s70 offen offset:1024 lds
  buffer_load_dwordx4 v223, s[44:47], s70 offen offset:2048 lds
  buffer_load_dwordx4 v224, s[44:47], s70 offen offset:3072 lds
  s_add_u32 m0, s90, 114688
  s_xor_b32 s70, s95, 4
  s_add_u32 s70, s70, s92
  s_and_b32 s70, s70, 15
  s_mul_i32 s70, s70, 57344
  s_add_u32 s70, s70, s81
  buffer_load_dwordx4 v230, s[52:55], s70 offen sc1 lds
  buffer_load_dwordx4 v230, s[52:55], s70 offen offset:1024 sc1 lds
  buffer_load_dwordx4 v230, s[52:55], s70 offen offset:2048 sc1 lds
  s_mov_b32 exec_hi, 0
  buffer_load_dwordx4 v230, s[52:55], s70 offen offset:3072 sc1 lds
  s_mov_b32 exec_hi, -1
  s_waitcnt vmcnt(24)
  s_barrier
  s_add_u32 m0, s91, 0
  s_xor_b32 s70, s95, 5
  s_add_u32 s70, s70, s92
  s_and_b32 s70, s70, 15
  s_mul_i32 s70, s70, 128
  s_add_u32 s70, s70, s80
  buffer_load_dwordx4 v221, s[44:47], s70 offen lds
  buffer_load_dwordx4 v222, s[44:47], s70 offen offset:1024 lds
  buffer_load_dwordx4 v223, s[44:47], s70 offen offset:2048 lds
  buffer_load_dwordx4 v224, s[44:47], s70 offen offset:3072 lds
  s_add_u32 m0, s90, 131072
  s_xor_b32 s70, s95, 5
  s_add_u32 s70, s70, s92
  s_and_b32 s70, s70, 15
  s_mul_i32 s70, s70, 57344
  s_add_u32 s70, s70, s81
  buffer_load_dwordx4 v230, s[52:55], s70 offen sc1 lds
  buffer_load_dwordx4 v230, s[52:55], s70 offen offset:1024 sc1 lds
  buffer_load_dwordx4 v230, s[52:55], s70 offen offset:2048 sc1 lds
  s_mov_b32 exec_hi, 0
  buffer_load_dwordx4 v230, s[52:55], s70 offen offset:3072 sc1 lds
  s_mov_b32 exec_hi, -1
  s_waitcnt vmcnt(24)
  s_barrier
  s_add_u32 m0, s91, 16384
  s_xor_b32 s70, s95, 6
  s_add_u32 s70, s70, s92
  s_and_b32 s70, s70, 15
  s_mul_i32 s70, s70, 128
  s_add_u32 s70, s70, s80
  buffer_load_dwordx4 v221, s[44:47], s70 offen lds
  buffer_load_dwordx4 v222, s[44:47], s70 offen offset:1024 lds
  buffer_load_dwordx4 v223, s[44:47], s70 offen offset:2048 lds
  buffer_load_dwordx4 v224, s[44:47], s70 offen offset:3072 lds
  s_add_u32 m0, s90, 147456
  s_xor_b32 s70, s95, 6
  s_add_u32 s70, s70, s92
  s_and_b32 s70, s70, 15
  s_mul_i32 s70, s70, 57344
  s_add_u32 s70, s70, s81
  buffer_load_dwordx4 v230, s[52:55], s70 offen sc1 lds
  buffer_load_dwordx4 v230, s[52:55], s70 offen offset:1024 sc1 lds
  buffer_load_dwordx4 v230, s[52:55], s70 offen offset:2048 sc1 lds
  s_mov_b32 exec_hi, 0
  buffer_load_dwordx4 v230, s[52:55], s70 offen offset:3072 sc1 lds
  s_mov_b32 exec_hi, -1
  s_waitcnt vmcnt(24)
  s_barrier
  s_add_u32 m0, s91, 32768
  s_xor_b32 s70, s95, 7
  s_add_u32 s70, s70, s92
  s_and_b32 s70, s70, 15
  s_mul_i32 s70, s70, 128
  s_add_u32 s70, s70, s80
  buffer_load_dwordx4 v221, s[44:47], s70 offen lds
  buffer_load_dwordx4 v222, s[44:47], s70 offen offset:1024 lds
  buffer_load_dwordx4 v223, s[44:47], s70 offen offset:2048 lds
  buffer_load_dwordx4 v224, s[44:47], s70 offen offset:3072 lds
  s_add_u32 m0, s90, 49152
  s_xor_b32 s70, s95, 7
  s_add_u32 s70, s70, s92
  s_and_b32 s70, s70, 15
  s_mul_i32 s70, s70, 57344
  s_add_u32 s70, s70, s81
  buffer_load_dwordx4 v230, s[52:55], s70 offen sc1 lds
  buffer_load_dwordx4 v230, s[52:55], s70 offen offset:1024 sc1 lds
  buffer_load_dwordx4 v230, s[52:55], s70 offen offset:2048 sc1 lds
  s_mov_b32 exec_hi, 0
  buffer_load_dwordx4 v230, s[52:55], s70 offen offset:3072 sc1 lds
  s_mov_b32 exec_hi, -1
  s_waitcnt vmcnt(24)
  s_barrier
  s_waitcnt vmcnt(16)
  s_barrier
  s_waitcnt vmcnt(8)
  s_barrier
  s_add_u32 m0, s88, 65536
  s_nop 0
  buffer_load_dwordx4 v229, s[52:55], s82 offen sc1 lds
  buffer_load_dwordx4 v229, s[52:55], s82 offen offset:1024 sc1 lds
  s_add_u32 m0, s88, 73728
  s_nop 0
  buffer_load_dwordx4 v229, s[52:55], s83 offen sc1 lds
  buffer_load_dwordx4 v229, s[52:55], s83 offen offset:1024 sc1 lds
  s_add_u32 m0, s88, 81920
  s_nop 0
  buffer_load_dwordx4 v229, s[52:55], s84 offen sc1 lds
  buffer_load_dwordx4 v229, s[52:55], s84 offen offset:1024 sc1 lds
  s_add_u32 m0, s88, 90112
  s_nop 0
  buffer_load_dwordx4 v229, s[52:55], s85 offen sc1 lds
  buffer_load_dwordx4 v229, s[52:55], s85 offen offset:1024 sc1 lds
  s_waitcnt vmcnt(8)
  s_barrier
  s_add_u32 m0, s88, 98304
  s_add_u32 s70, s82, 2097152
  buffer_load_dwordx4 v229, s[52:55], s70 offen sc1 lds
  buffer_load_dwordx4 v229, s[52:55], s70 offen offset:1024 sc1 lds
  s_add_u32 m0, s88, 106496
  s_add_u32 s70, s83, 2097152
  buffer_load_dwordx4 v229, s[52:55], s70 offen sc1 lds
  buffer_load_dwordx4 v229, s[52:55], s70 offen offset:1024 sc1 lds
  s_add_u32 m0, s88, 114688
  s_add_u32 s70, s84, 2097152
  buffer_load_dwordx4 v229, s[52:55], s70 offen sc1 lds
  buffer_load_dwordx4 v229, s[52:55], s70 offen offset:1024 sc1 lds
  s_waitcnt vmcnt(6)
  s_cmp_ge_u32 s66, 4
  s_cbranch_scc1 L_kf_9
  ds_write_b128 v232, v[204:207]
  ds_write_b128 v232, v[204:207] offset:1024
  s_cmp_ge_u32 s66, 2
  s_cbranch_scc1 L_kf_9
  ds_write_b128 v232, v[204:207] offset:8192
  ds_write_b128 v232, v[204:207] offset:9216
L_kf_9:
  s_waitcnt lgkmcnt(0)
  s_barrier
  s_add_u32 m0, s91, 0
  s_xor_b32 s70, s75, 8
  s_add_u32 s70, s70, s92
  s_and_b32 s70, s70, 15
  s_mul_i32 s70, s70, 128
  s_add_u32 s70, s70, s80
  buffer_load_dwordx4 v221, s[44:47], s70 offen lds
  buffer_load_dwordx4 v222, s[44:47], s70 offen offset:1024 lds
  buffer_load_dwordx4 v223, s[44:47], s70 offen offset:2048 lds
  buffer_load_dwordx4 v224, s[44:47], s70 offen offset:3072 lds
  s_add_u32 m0, s91, 16384
  s_xor_b32 s70, s75, 9
  s_add_u32 s70, s70, s92
  s_and_b32 s70, s70, 15
  s_mul_i32 s70, s70, 128
  s_add_u32 s70, s70, s80
  buffer_load_dwordx4 v221, s[44:47], s70 offen lds
  buffer_load_dwordx4 v222, s[44:47], s70 offen offset:1024 lds
  buffer_load_dwordx4 v223, s[44:47], s70 offen offset:2048 lds
  buffer_load_dwordx4 v224, s[44:47], s70 offen offset:3072 lds
  s_and_b32 s70, s65, 1
  s_lshl_b32 s70, s70, 3
  s_lshr_b32 s71, s66, 2
  s_add_u32 s70, s70, s71
  s_lshl_b32 s70, s70, 2
  s_lshr_b32 s71, s65, 1
  s_add_u32 s70, s70, s71
  s_mul_i32 s5, s70, 57344
  s_and_b32 s70, s66, 3
  s_mul_i32 s70, s70, 224
  s_add_u32 s5, s5, s70
  s_add_u32 s5, s5, 896
  s_and_b32 s70, s65, 1
  s_lshl_b32 s70, s70, 5
  s_add_u32 s70, s70, s66
  s_lshl_b32 s70, s70, 2
  s_add_u32 s70, s70, s71
  s_mul_i32 s4, s70, 28672
  s_add_u32 s4, s4, 12582912
  s_add_u32 s70, s71, 1
  s_and_b32 s70, s70, 3
  s_mul_i32 s70, s70, 7168
  s_add_u32 s8, s4, s70
  s_add_u32 s70, s71, 2
  s_and_b32 s70, s70, 3
  s_mul_i32 s70, s70, 7168
  s_add_u32 s9, s4, s70
  s_add_u32 s70, s71, 3
  s_and_b32 s70, s70, 3
  s_mul_i32 s70, s70, 7168
  s_add_u32 s10, s4, s70
  v_lshlrev_b32 v9, 4, v1
  s_lshl_b32 s70, s67, 10
  v_add_u32 v10, s70, v9
  s_cmp_eq_u32 s67, 3
  s_cselect_b32 s70, 0x40000000, 4096
  v_add_u32 v13, s70, v10
  s_lshl_b32 s70, s67, 2
  s_add_u32 s70, s70, 7168
  v_add_u32 v15, s70, v9
  v_mul_u32_u24 v11, 1792, v3
  v_lshl_add_u32 v12, v2, 3, v11
  v_lshl_add_u32 v11, v2, 4, v11
  s_mov_b32 s6, 0xffff0000
  s_mov_b32 s72, 79872
  s_cmp_eq_u32 s67, 1
  s_cselect_b32 s72, 96256, s72
  s_cmp_eq_u32 s67, 2
  s_cselect_b32 s72, 112640, s72
  s_cmp_eq_u32 s67, 3
  s_cselect_b32 s72, 129024, s72
  v_add_u32 v16, s72, v9
  s_mov_b32 s72, 80896
  s_cmp_eq_u32 s67, 1
  s_cselect_b32 s72, 97280, s72
  s_cmp_eq_u32 s67, 2
  s_cselect_b32 s72, 113664, s72
  s_cmp_eq_u32 s67, 3
  s_cselect_b32 s72, 130048, s72
  v_add_u32 v17, s72, v9
  s_waitcnt vmcnt(8)
  s_barrier
  s_add_u32 m0, s90, 131072
  s_xor_b32 s70, s75, 8
  s_add_u32 s70, s70, s92
  s_and_b32 s70, s70, 15
  s_mul_i32 s70, s70, 57344
  s_add_u32 s70, s70, s81
  buffer_load_dwordx4 v230, s[52:55], s70 offen sc1 lds
  buffer_load_dwordx4 v230, s[52:55], s70 offen offset:1024 sc1 lds
  buffer_load_dwordx4 v230, s[52:55], s70 offen offset:2048 sc1 lds
  s_mov_b32 exec_hi, 0
  buffer_load_dwordx4 v230, s[52:55], s70 offen offset:3072 sc1 lds
  s_mov_b32 exec_hi, -1
  s_add_u32 m0, s90, 147456
  s_xor_b32 s70, s75, 9
  s_add_u32 s70, s70, s92
  s_and_b32 s70, s70, 15
  s_mul_i32 s70, s70, 57344
  s_add_u32 s70, s70, s81
  buffer_load_dwordx4 v230, s[52:55], s70 offen sc1 lds
  buffer_load_dwordx4 v230, s[52:55], s70 offen offset:1024 sc1 lds
  buffer_load_dwordx4 v230, s[52:55], s70 offen offset:2048 sc1 lds
  s_mov_b32 exec_hi, 0
  buffer_load_dwordx4 v230, s[52:55], s70 offen offset:3072 sc1 lds
  s_mov_b32 exec_hi, -1
  s_add_u32 m0, s91, 32768
  s_xor_b32 s70, s75, 10
  s_add_u32 s70, s70, s92
  s_and_b32 s70, s70, 15
  s_mul_i32 s70, s70, 128
  s_add_u32 s70, s70, s80
  buffer_load_dwordx4 v221, s[44:47], s70 offen lds
  buffer_load_dwordx4 v222, s[44:47], s70 offen offset:1024 lds
  buffer_load_dwordx4 v223, s[44:47], s70 offen offset:2048 lds
  buffer_load_dwordx4 v224, s[44:47], s70 offen offset:3072 lds
  s_add_u32 m0, s90, 49152
  s_xor_b32 s70, s75, 10
  s_add_u32 s70, s70, s92
  s_and_b32 s70, s70, 15
  s_mul_i32 s70, s70, 57344
  s_add_u32 s70, s70, s81
  buffer_load_dwordx4 v230, s[52:55], s70 offen sc1 lds
  buffer_load_dwordx4 v230, s[52:55], s70 offen offset:1024 sc1 lds
  buffer_load_dwordx4 v230, s[52:55], s70 offen offset:2048 sc1 lds
  s_mov_b32 exec_hi, 0
  buffer_load_dwordx4 v230, s[52:55], s70 offen offset:3072 sc1 lds
  s_mov_b32 exec_hi, -1
  s_add_u32 m0, s91, 65536
  s_xor_b32 s70, s75, 11
  s_add_u32 s70, s70, s92
  s_and_b32 s70, s70, 15
  s_mul_i32 s70, s70, 128
  s_add_u32 s70, s70, s80
  buffer_load_dwordx4 v221, s[44:47], s70 offen lds
  buffer_load_dwordx4 v222, s[44:47], s70 offen offset:1024 lds
  buffer_load_dwordx4 v223, s[44:47], s70 offen offset:2048 lds
  buffer_load_dwordx4 v224, s[44:47], s70 offen offset:3072 lds
  s_add_u32 m0, s90, 81920
  s_xor_b32 s70, s75, 11
  s_add_u32 s70, s70, s92
  s_and_b32 s70, s70, 15
  s_mul_i32 s70, s70, 57344
  s_add_u32 s70, s70, s81
  buffer_load_dwordx4 v230, s[52:55], s70 offen sc1 lds
  buffer_load_dwordx4 v230, s[52:55], s70 offen offset:1024 sc1 lds
  buffer_load_dwordx4 v230, s[52:55], s70 offen offset:2048 sc1 lds
  s_mov_b32 exec_hi, 0
  buffer_load_dwordx4 v230, s[52:55], s70 offen offset:3072 sc1 lds
  s_mov_b32 exec_hi, -1
  s_waitcnt vmcnt(20)
  s_barrier
  s_add_u32 m0, s91, 98304
  s_xor_b32 s70, s75, 12
  s_add_u32 s70, s70, s92
  s_and_b32 s70, s70, 15
  s_mul_i32 s70, s70, 128
  s_add_u32 s70, s70, s80
  buffer_load_dwordx4 v221, s[44:47], s70 offen lds
  buffer_load_dwordx4 v222, s[44:47], s70 offen offset:1024 lds
  buffer_load_dwordx4 v223, s[44:47], s70 offen offset:2048 lds
  buffer_load_dwordx4 v224, s[44:47], s70 offen offset:3072 lds
  s_add_u32 m0, s90, 114688
  s_xor_b32 s70, s75, 12
  s_add_u32 s70, s70, s92
  s_and_b32 s70, s70, 15
  s_mul_i32 s70, s70, 57344
  s_add_u32 s70, s70, s81
  buffer_load_dwordx4 v230, s[52:55], s70 offen sc1 lds
  buffer_load_dwordx4 v230, s[52:55], s70 offen offset:1024 sc1 lds
  buffer_load_dwordx4 v230, s[52:55], s70 offen offset:2048 sc1 lds
  s_mov_b32 exec_hi, 0
  buffer_load_dwordx4 v230, s[52:55], s70 offen offset:3072 sc1 lds
  s_mov_b32 exec_hi, -1
  s_waitcnt vmcnt(24)
  s_barrier
  s_add_u32 m0, s91, 0
  s_xor_b32 s70, s75, 13
  s_add_u32 s70, s70, s92
  s_and_b32 s70, s70, 15
  s_mul_i32 s70, s70, 128
  s_add_u32 s70, s70, s80
  buffer_load_dwordx4 v221, s[44:47], s70 offen lds
  buffer_load_dwordx4 v222, s[44:47], s70 offen offset:1024 lds
  buffer_load_dwordx4 v223, s[44:47], s70 offen offset:2048 lds
  buffer_load_dwordx4 v224, s[44:47], s70 offen offset:3072 lds
  s_add_u32 m0, s90, 131072
  s_xor_b32 s70, s75, 13
  s_add_u32 s70, s70, s92
  s_and_b32 s70, s70, 15
  s_mul_i32 s70, s70, 57344
  s_add_u32 s70, s70, s81
  buffer_load_dwordx4 v230, s[52:55], s70 offen sc1 lds
  buffer_load_dwordx4 v230, s[52:55], s70 offen offset:1024 sc1 lds
  buffer_load_dwordx4 v230, s[52:55], s70 offen offset:2048 sc1 lds
  s_mov_b32 exec_hi, 0
  buffer_load_dwordx4 v230, s[52:55], s70 offen offset:3072 sc1 lds
  s_mov_b32 exec_hi, -1
  s_waitcnt vmcnt(24)
  s_barrier
  s_add_u32 m0, s91, 16384
  s_xor_b32 s70, s75, 14
  s_add_u32 s70, s70, s92
  s_and_b32 s70, s70, 15
  s_mul_i32 s70, s70, 128
  s_add_u32 s70, s70, s80
  buffer_load_dwordx4 v221, s[44:47], s70 offen lds
  buffer_load_dwordx4 v222, s[44:47], s70 offen offset:1024 lds
  buffer_load_dwordx4 v223, s[44:47], s70 offen offset:2048 lds
  buffer_load_dwordx4 v224, s[44:47], s70 offen offset:3072 lds
  s_add_u32 m0, s90, 147456
  s_xor_b32 s70, s75, 14
  s_add_u32 s70, s70, s92
  s_and_b32 s70, s70, 15
  s_mul_i32 s70, s70, 57344
  s_add_u32 s70, s70, s81
  buffer_load_dwordx4 v230, s[52:55], s70 offen sc1 lds
  buffer_load_dwordx4 v230, s[52:55], s70 offen offset:1024 sc1 lds
  buffer_load_dwordx4 v230, s[52:55], s70 offen offset:2048 sc1 lds
  s_mov_b32 exec_hi, 0
  buffer_load_dwordx4 v230, s[52:55], s70 offen offset:3072 sc1 lds
  s_mov_b32 exec_hi, -1
  s_waitcnt vmcnt(24)
  s_barrier
  s_add_u32 m0, s91, 32768
  s_xor_b32 s70, s75, 15
  s_add_u32 s70, s70, s92
  s_and_b32 s70, s70, 15
  s_mul_i32 s70, s70, 128
  s_add_u32 s70, s70, s80
  buffer_load_dwordx4 v221, s[44:47], s70 offen lds
  buffer_load_dwordx4 v222, s[44:47], s70 offen offset:1024 lds
  buffer_load_dwordx4 v223, s[44:47], s70 offen offset:2048 lds
  buffer_load_dwordx4 v224, s[44:47], s70 offen offset:3072 lds
  s_add_u32 m0, s90, 49152
  s_xor_b32 s70, s75, 15
  s_add_u32 s70, s70, s92
  s_and_b32 s70, s70, 15
  s_mul_i32 s70, s70, 57344
  s_add_u32 s70, s70, s81
  buffer_load_dwordx4 v230, s[52:55], s70 offen sc1 lds
  buffer_load_dwordx4 v230, s[52:55], s70 offen offset:1024 sc1 lds
  buffer_load_dwordx4 v230, s[52:55], s70 offen offset:2048 sc1 lds
  s_mov_b32 exec_hi, 0
  buffer_load_dwordx4 v230, s[52:55], s70 offen offset:3072 sc1 lds
  s_mov_b32 exec_hi, -1
  s_waitcnt vmcnt(24)
  s_barrier
  s_add_u32 m0, s90, 65536
  s_nop 0
  buffer_load_dwordx4 v225, s[36:39], s86 offen lds
  buffer_load_dwordx4 v226, s[36:39], s86 offen offset:1024 lds
  buffer_load_dwordx4 v227, s[36:39], s86 offen offset:2048 lds
  s_mov_b32 exec_hi, 0
  buffer_load_dwordx4 v228, s[36:39], s86 offen offset:3072 lds
  s_mov_b32 exec_hi, -1
  s_add_u32 m0, s90, 81920
  s_add_u32 s70, s86, 100352
  buffer_load_dwordx4 v225, s[36:39], s70 offen lds
  buffer_load_dwordx4 v226, s[36:39], s70 offen offset:1024 lds
  buffer_load_dwordx4 v227, s[36:39], s70 offen offset:2048 lds
  s_mov_b32 exec_hi, 0
  buffer_load_dwordx4 v228, s[36:39], s70 offen offset:3072 lds
  s_mov_b32 exec_hi, -1
  s_waitcnt vmcnt(24)
  s_barrier
  s_bfe_u32 s70, s66, 0x10001
  s_lshl_b32 s71, s65, 1
  s_add_u32 s70, s70, s71
  s_lshl_b32 s70, s70, 7
  s_and_b32 s71, s66, 1
  s_lshl_b32 s71, s71, 1
  s_add_u32 s70, s70, s71
  v_and_b32 v4, 1, v3
  v_lshrrev_b32 v39, 1, v3
  v_lshl_add_u32 v39, v4, 3, v39
  v_lshlrev_b32 v39, 3, v39
  v_add_u32 v39, s70, v39
  v_and_b32 v4, 1, v2
  v_add_u32 v39, v39, v4
  v_and_b32 v4, 7, v39
  v_lshrrev_b32 v39, 3, v39
  v_lshlrev_b32 v39, 7, v39
  v_lshl_add_u32 v39, v4, 2, v39
  v_add_u32 v39, 21037056, v39
  buffer_load_dword v38, v39, s[52:55], 0 offen sc1
  s_add_u32 m0, s90, 98304
  s_add_u32 s70, s86, 200704
  buffer_load_dwordx4 v225, s[36:39], s70 offen lds
  buffer_load_dwordx4 v226, s[36:39], s70 offen offset:1024 lds
  buffer_load_dwordx4 v227, s[36:39], s70 offen offset:2048 lds
  s_mov_b32 exec_hi, 0
  buffer_load_dwordx4 v228, s[36:39], s70 offen offset:3072 lds
  s_mov_b32 exec_hi, -1
  s_add_u32 m0, s90, 114688
  s_add_u32 s70, s86, 301056
  buffer_load_dwordx4 v225, s[36:39], s70 offen lds
  buffer_load_dwordx4 v226, s[36:39], s70 offen offset:1024 lds
  buffer_load_dwordx4 v227, s[36:39], s70 offen offset:2048 lds
  s_mov_b32 exec_hi, 0
  buffer_load_dwordx4 v228, s[36:39], s70 offen offset:3072 lds
  s_mov_b32 exec_hi, -1
  s_waitcnt vmcnt(25)
  s_barrier
  s_waitcnt vmcnt(8)
  v_cmp_ne_u32 vcc, s68, v38
  s_nop 1
  s_cbranch_vccz L_fast_10
  s_mov_b32 s69, 0
L_sp_11:
  s_waitcnt vmcnt(0)
  v_cmp_ne_u32 vcc, s68, v38
  s_nop 1
  s_cbranch_vccz L_ok_12
  s_mov_b64 exec, vcc
  s_add_u32 s69, s69, 1
  s_cmp_ge_u32 s69, 0x40000
  s_cbranch_scc1 L_ok_12
  s_sleep 1
  buffer_load_dword v38, v39, s[52:55], 0 offen sc1
  s_branch L_sp_11
L_ok_12:
  s_mov_b64 exec, -1
L_fast_10:
  s_add_u32 m0, s91, 0
  s_nop 0
  buffer_load_dwordx4 v231, s[52:55], s87 offen sc1 lds
  buffer_load_dwordx4 v231, s[52:55], s87 offen offset:1024 sc1 lds
  buffer_load_dwordx4 v231, s[52:55], s87 offen offset:2048 sc1 lds
  buffer_load_dwordx4 v231, s[52:55], s87 offen offset:3072 sc1 lds
  s_add_u32 m0, s91, 131072
  s_add_u32 s70, s87, 4096
  buffer_load_dwordx4 v231, s[52:55], s70 offen sc1 lds
  buffer_load_dwordx4 v231, s[52:55], s70 offen offset:1024 sc1 lds
  buffer_load_dwordx4 v231, s[52:55], s70 offen offset:2048 sc1 lds
  buffer_load_dwordx4 v231, s[52:55], s70 offen offset:3072 sc1 lds
  s_barrier
  s_add_u32 m0, s91, 16384
  s_add_u32 s70, s87, 8192
  buffer_load_dwordx4 v231, s[52:55], s70 offen sc1 lds
  buffer_load_dwordx4 v231, s[52:55], s70 offen offset:1024 sc1 lds
  buffer_load_dwordx4 v231, s[52:55], s70 offen offset:2048 sc1 lds
  buffer_load_dwordx4 v231, s[52:55], s70 offen offset:3072 sc1 lds
  s_add_u32 m0, s91, 147456
  s_add_u32 s70, s87, 12288
  buffer_load_dwordx4 v231, s[52:55], s70 offen sc1 lds
  buffer_load_dwordx4 v231, s[52:55], s70 offen offset:1024 sc1 lds
  buffer_load_dwordx4 v231, s[52:55], s70 offen offset:2048 sc1 lds
  buffer_load_dwordx4 v231, s[52:55], s70 offen offset:3072 sc1 lds
  s_barrier
  s_lshl_b32 s70, s66, 3
  s_and_b32 s71, s65, 1
  s_add_u32 s70, s70, s71
  s_lshl_b32 s70, s70, 3
  s_lshr_b32 s71, s65, 1
  s_add_u32 s70, s70, s71
  v_and_b32 v39, 3, v1
  v_lshl_add_u32 v39, v39, 4, s70
  v_and_b32 v4, 7, v39
  v_lshrrev_b32 v39, 3, v39
  v_lshlrev_b32 v39, 7, v39
  v_lshl_add_u32 v39, v4, 2, v39
  v_add_u32 v39, 21069824, v39
  s_waitcnt vmcnt(0)
  s_barrier
  buffer_load_dword v38, v39, s[52:55], 0 offen sc1
  ds_read_b128 v[104:107], v16
  ds_read_b128 v[108:111], v17
  s_waitcnt lgkmcnt(0)
  v_lshlrev_b32 v80, 16, v104
  v_and_b32 v81, s6, v104
  v_lshlrev_b32 v82, 16, v105
  v_and_b32 v83, s6, v105
  v_lshlrev_b32 v84, 16, v106
  v_and_b32 v85, s6, v106
  v_lshlrev_b32 v86, 16, v107
  v_and_b32 v87, s6, v107
  v_lshlrev_b32 v88, 16, v108
  v_and_b32 v89, s6, v108
  v_lshlrev_b32 v90, 16, v109
  v_and_b32 v91, s6, v109
  v_lshlrev_b32 v92, 16, v110
  v_and_b32 v93, s6, v110
  v_lshlrev_b32 v94, 16, v111
  v_and_b32 v95, s6, v111
  s_mov_b32 s69, 0
L_sp_13:
  s_waitcnt vmcnt(0)
  v_cmp_ne_u32 vcc, s68, v38
  s_nop 1
  s_cbranch_vccz L_ok_14
  s_mov_b64 exec, vcc
  s_add_u32 s69, s69, 1
  s_cmp_ge_u32 s69, 0x40000
  s_cbranch_scc1 L_ok_14
  s_sleep 1
  buffer_load_dword v38, v39, s[52:55], 0 offen sc1
  s_branch L_sp_13
L_ok_14:
  s_mov_b64 exec, -1
  buffer_load_dwordx4 v[40:43], v10, s[52:55], s8 offen sc1
  buffer_load_dwordx4 v[44:47], v10, s[52:55], s9 offen sc1
  buffer_load_dwordx4 v[48:51], v10, s[52:55], s10 offen sc1
  buffer_load_dwordx4 v[52:55], v13, s[52:55], s8 offen sc1
  buffer_load_dwordx4 v[56:59], v13, s[52:55], s9 offen sc1
  buffer_load_dwordx4 v[60:63], v13, s[52:55], s10 offen sc1
  s_waitcnt vmcnt(5)
  v_lshlrev_b32 v100, 16, v40
  v_and_b32 v101, s6, v40
  v_pk_add_f32 v[80:81], v[80:81], v[100:101]
  v_lshlrev_b32 v102, 16, v41
  v_and_b32 v103, s6, v41
  v_pk_add_f32 v[82:83], v[82:83], v[102:103]
  v_lshlrev_b32 v100, 16, v42
  v_and_b32 v101, s6, v42
  v_pk_add_f32 v[84:85], v[84:85], v[100:101]
  v_lshlrev_b32 v102, 16, v43
  v_and_b32 v103, s6, v43
  v_pk_add_f32 v[86:87], v[86:87], v[102:103]
  s_waitcnt vmcnt(4)
  v_lshlrev_b32 v100, 16, v44
  v_and_b32 v101, s6, v44
  v_pk_add_f32 v[80:81], v[80:81], v[100:101]
  v_lshlrev_b32 v102, 16, v45
  v_and_b32 v103, s6, v45
  v_pk_add_f32 v[82:83], v[82:83], v[102:103]
  v_lshlrev_b32 v100, 16, v46
  v_and_b32 v101, s6, v46
  v_pk_add_f32 v[84:85], v[84:85], v[100:101]
  v_lshlrev_b32 v102, 16, v47
  v_and_b32 v103, s6, v47
  v_pk_add_f32 v[86:87], v[86:87], v[102:103]
  s_waitcnt vmcnt(3)
  v_lshlrev_b32 v100, 16, v48
  v_and_b32 v101, s6, v48
  v_pk_add_f32 v[80:81], v[80:81], v[100:101]
  v_lshlrev_b32 v102, 16, v49
  v_and_b32 v103, s6, v49
  v_pk_add_f32 v[82:83], v[82:83], v[102:103]
  v_lshlrev_b32 v100, 16, v50
  v_and_b32 v101, s6, v50
  v_pk_add_f32 v[84:85], v[84:85], v[100:101]
  v_lshlrev_b32 v102, 16, v51
  v_and_b32 v103, s6, v51
  v_pk_add_f32 v[86:87], v[86:87], v[102:103]
  v_cvt_pk_bf16_f32 v80, v80, v81
  v_cvt_pk_bf16_f32 v81, v82, v83
  v_cvt_pk_bf16_f32 v82, v84, v85
  v_cvt_pk_bf16_f32 v83, v86, v87
  s_lshl_b32 s70, s67, 6
  s_cmp_eq_u32 s67, 3
  s_cselect_b32 s70, 28672, s70
  s_add_u32 s70, s70, s5
  buffer_store_dwordx4 v[80:83], v11, s[56:59], s70 offen
  s_waitcnt vmcnt(3)
  v_lshlrev_b32 v100, 16, v52
  v_and_b32 v101, s6, v52
  v_pk_add_f32 v[88:89], v[88:89], v[100:101]
  v_lshlrev_b32 v102, 16, v53
  v_and_b32 v103, s6, v53
  v_pk_add_f32 v[90:91], v[90:91], v[102:103]
  v_lshlrev_b32 v100, 16, v54
  v_and_b32 v101, s6, v54
  v_pk_add_f32 v[92:93], v[92:93], v[100:101]
  v_lshlrev_b32 v102, 16, v55
  v_and_b32 v103, s6, v55
  v_pk_add_f32 v[94:95], v[94:95], v[102:103]
  s_waitcnt vmcnt(2)
  v_lshlrev_b32 v100, 16, v56
  v_and_b32 v101, s6, v56
  v_pk_add_f32 v[88:89], v[88:89], v[100:101]
  v_lshlrev_b32 v102, 16, v57
  v_and_b32 v103, s6, v57
  v_pk_add_f32 v[90:91], v[90:91], v[102:103]
  v_lshlrev_b32 v100, 16, v58
  v_and_b32 v101, s6, v58
  v_pk_add_f32 v[92:93], v[92:93], v[100:101]
  v_lshlrev_b32 v102, 16, v59
  v_and_b32 v103, s6, v59
  v_pk_add_f32 v[94:95], v[94:95], v[102:103]
  s_waitcnt vmcnt(1)
  v_lshlrev_b32 v100, 16, v60
  v_and_b32 v101, s6, v60
  v_pk_add_f32 v[88:89], v[88:89], v[100:101]
  v_lshlrev_b32 v102, 16, v61
  v_and_b32 v103, s6, v61
  v_pk_add_f32 v[90:91], v[90:91], v[102:103]
  v_lshlrev_b32 v100, 16, v62
  v_and_b32 v101, s6, v62
  v_pk_add_f32 v[92:93], v[92:93], v[100:101]
  v_lshlrev_b32 v102, 16, v63
  v_and_b32 v103, s6, v63
  v_pk_add_f32 v[94:95], v[94:95], v[102:103]
  v_cvt_pk_bf16_f32 v88, v88, v89
  v_cvt_pk_bf16_f32 v89, v90, v91
  v_cvt_pk_bf16_f32 v90, v92, v93
  v_cvt_pk_bf16_f32 v91, v94, v95
  s_cmp_ge_u32 s67, 2
  s_cbranch_scc1 L_r6_15
  s_lshl_b32 s70, s67, 6
  s_add_u32 s70, s70, 28736
  s_add_u32 s70, s70, s5
  buffer_store_dwordx4 v[88:91], v11, s[56:59], s70 offen
  s_branch L_re_16
L_r6_15:
  s_cmp_eq_u32 s67, 2
  s_cbranch_scc0 L_re_16
  s_add_u32 s70, s5, 192
  s_add_u32 s71, s5, 28864
  buffer_store_dwordx2 v[88:89], v12, s[56:59], s70 offen
  buffer_store_dwordx2 v[90:91], v12, s[56:59], s71 offen
L_re_16:
  s_branch L_end_1
L_compute_2:
  s_getpc_b64 s[88:89]
L_pc_17:
  s_sub_u32 s88, s88, L_pc_17-concat_heads__sliding_block__spectral_fnet__prompt_kernel
  s_subb_u32 s89, s89, 0
  s_and_b32 s89, s89, 0xffff
  s_mov_b32 s90, L_end_1-concat_heads__sliding_block__spectral_fnet__prompt_kernel
  s_mov_b32 s91, 0x20000
  s_and_b32 s70, s66, 3
  s_lshl_b32 s70, s70, 13
  s_lshl_b32 s71, s64, 20
  s_add_u32 s70, s70, s71
  v_lshlrev_b32 v28, 7, v1
  s_mov_b32 s27, s70
  buffer_load_dword v198, v28, s[88:91], s27 offen
  s_lshl_b32 s26, s2, 5
  s_add_u32 s26, s26, s64
  s_lshl_b32 s26, s26, 2
  s_add_u32 s26, s26, 20971520
  s_waitcnt lgkmcnt(0)
  s_mov_b32 s52, s24
  s_and_b32 s53, s25, 0xffff
  s_mov_b32 s54, 268435456
  s_mov_b32 s55, 0x20000
  s_mov_b32 s56, s20
  s_and_b32 s57, s21, 0xffff
  s_mov_b32 s58, 3670016
  s_mov_b32 s59, 0x20000
  s_mov_b32 s60, s22
  s_and_b32 s61, s23, 0xffff
  s_mov_b32 s62, 256
  s_mov_b32 s63, 0x20000
  s_lshl_b32 s70, s2, 2
  s_or_b32 s70, s70, s64
  s_cmp_eq_u32 s70, 3
  s_cbranch_scc0 L_nn_18
  s_memrealtime s[92:93]
  s_waitcnt lgkmcnt(0)
  s_or_b32 s92, s92, 1
  v_mov_b32 v4, s92
  s_mov_b64 exec, 1
  buffer_store_dword v4, v37, s[60:63], 0 offen sc1
  s_mov_b64 exec, -1
L_nn_18:
  v_and_b32 v4, 7, v3
  v_xor_b32 v4, v4, v2
  v_lshlrev_b32 v4, 4, v4
  v_lshl_add_u32 v16, v3, 7, v4
  v_xor_b32 v19, 64, v16
  s_and_b32 s70, s64, 1
  s_lshl_b32 s70, s70, 12
  v_add_u32 v10, s70, v16
  v_add_u32 v13, s70, v19
  v_add_u32 v11, 0x10000, v10
  v_add_u32 v12, 0x20000, v10
  v_add_u32 v14, 0x10000, v13
  v_add_u32 v15, 0x20000, v13
  v_add_u32 v17, 0x10000, v16
  v_add_u32 v18, 0x20000, v16
  v_add_u32 v20, 0x10000, v19
  v_add_u32 v21, 0x20000, v19
  v_lshlrev_b32 v5, 4, v1
  s_lshl_b32 s70, s65, 3
  s_and_b32 s71, s66, 7
  s_add_u32 s70, s70, s71
  s_mul_i32 s76, s70, 57344
  s_lshr_b32 s70, s66, 3
  s_lshl_b32 s70, s70, 1
  s_and_b32 s71, s64, 1
  s_add_u32 s70, s70, s71
  s_mul_i32 s70, s70, 7168
  s_add_u32 s76, s76, s70
  s_lshr_b32 s70, s64, 1
  s_lshl_b32 s70, s70, 12
  s_add_u32 s76, s76, s70
  s_cmp_ge_u32 s65, 4
  s_cselect_b32 s77, 0x80008000, 0
  s_cmp_ge_u32 s64, 2
  s_cselect_b32 s82, 0x40000000, s76
  v_mov_b32 v124, 0
  v_mov_b32 v140, 0
  v_mov_b32 v125, 0
  v_mov_b32 v141, 0
  v_mov_b32 v126, 0
  v_mov_b32 v142, 0
  v_mov_b32 v127, 0
  v_mov_b32 v143, 0
  s_barrier
  buffer_load_dword v38, v37, s[60:63], 0 offen sc1
  s_cmp_ge_u32 s64, 2
  s_cbranch_scc1 L_ab1_19
  ds_read_b128 v[40:43], v10 offset:0
  ds_read_b128 v[44:47], v10 offset:2048
  ds_read_b128 v[48:51], v16 offset:16384
  ds_read_b128 v[52:55], v16 offset:18432
  ds_read_b128 v[56:59], v16 offset:20480
  ds_read_b128 v[60:63], v16 offset:22528
  s_waitcnt lgkmcnt(0)
  v_mfma_f32_16x16x32_bf16 v[112:115], v[40:43], v[48:51], 0
  ds_read_b128 v[64:67], v13 offset:0
  v_mfma_f32_16x16x32_bf16 v[128:131], v[44:47], v[48:51], 0
  ds_read_b128 v[68:71], v13 offset:2048
  v_mfma_f32_16x16x32_bf16 v[116:119], v[40:43], v[52:55], 0
  ds_read_b128 v[72:75], v19 offset:16384
  v_mfma_f32_16x16x32_bf16 v[132:135], v[44:47], v[52:55], 0
  ds_read_b128 v[76:79], v19 offset:18432
  v_mfma_f32_16x16x32_bf16 v[120:123], v[40:43], v[56:59], 0
  ds_read_b128 v[80:83], v19 offset:20480
  v_mfma_f32_16x16x32_bf16 v[136:139], v[44:47], v[56:59], 0
  ds_read_b128 v[84:87], v19 offset:22528
  v_mfma_f32_16x16x32_bf16 v[124:127], v[40:43], v[60:63], 0
  v_mfma_f32_16x16x32_bf16 v[140:143], v[44:47], v[60:63], 0
  s_waitcnt lgkmcnt(0)
  s_barrier
  v_mfma_f32_16x16x32_bf16 v[112:115], v[64:67], v[72:75], v[112:115]
  ds_read_b128 v[40:43], v10 offset:32768
  v_mfma_f32_16x16x32_bf16 v[128:131], v[68:71], v[72:75], v[128:131]
  ds_read_b128 v[44:47], v10 offset:34816
  v_mfma_f32_16x16x32_bf16 v[116:119], v[64:67], v[76:79], v[116:119]
  ds_read_b128 v[48:51], v16 offset:49152
  v_mfma_f32_16x16x32_bf16 v[132:135], v[68:71], v[76:79], v[132:135]
  ds_read_b128 v[52:55], v16 offset:51200
  v_mfma_f32_16x16x32_bf16 v[120:123], v[64:67], v[80:83], v[120:123]
  ds_read_b128 v[56:59], v16 offset:53248
  v_mfma_f32_16x16x32_bf16 v[136:139], v[68:71], v[80:83], v[136:139]
  ds_read_b128 v[60:63], v16 offset:55296
  v_mfma_f32_16x16x32_bf16 v[124:127], v[64:67], v[84:87], v[124:127]
  v_mfma_f32_16x16x32_bf16 v[140:143], v[68:71], v[84:87], v[140:143]
  s_waitcnt lgkmcnt(0)
  v_mfma_f32_16x16x32_bf16 v[112:115], v[40:43], v[48:51], v[112:115]
  ds_read_b128 v[64:67], v13 offset:32768
  v_mfma_f32_16x16x32_bf16 v[128:131], v[44:47], v[48:51], v[128:131]
  ds_read_b128 v[68:71], v13 offset:34816
  v_mfma_f32_16x16x32_bf16 v[116:119], v[40:43], v[52:55], v[116:119]
  ds_read_b128 v[72:75], v19 offset:49152
  v_mfma_f32_16x16x32_bf16 v[132:135], v[44:47], v[52:55], v[132:135]
  ds_read_b128 v[76:79], v19 offset:51200
  v_mfma_f32_16x16x32_bf16 v[120:123], v[40:43], v[56:59], v[120:123]
  ds_read_b128 v[80:83], v19 offset:53248
  v_mfma_f32_16x16x32_bf16 v[136:139], v[44:47], v[56:59], v[136:139]
  ds_read_b128 v[84:87], v19 offset:55296
  v_mfma_f32_16x16x32_bf16 v[124:127], v[40:43], v[60:63], v[124:127]
  v_mfma_f32_16x16x32_bf16 v[140:143], v[44:47], v[60:63], v[140:143]
  s_waitcnt lgkmcnt(0)
  s_barrier
  v_mfma_f32_16x16x32_bf16 v[112:115], v[64:67], v[72:75], v[112:115]
  ds_read_b128 v[40:43], v11 offset:0
  v_mfma_f32_16x16x32_bf16 v[128:131], v[68:71], v[72:75], v[128:131]
  ds_read_b128 v[44:47], v11 offset:2048
  v_mfma_f32_16x16x32_bf16 v[116:119], v[64:67], v[76:79], v[116:119]
  ds_read_b128 v[48:51], v17 offset:16384
  v_mfma_f32_16x16x32_bf16 v[132:135], v[68:71], v[76:79], v[132:135]
  ds_read_b128 v[52:55], v17 offset:18432
  v_mfma_f32_16x16x32_bf16 v[120:123], v[64:67], v[80:83], v[120:123]
  ds_read_b128 v[56:59], v17 offset:20480
  v_mfma_f32_16x16x32_bf16 v[136:139], v[68:71], v[80:83], v[136:139]
  ds_read_b128 v[60:63], v17 offset:22528
  v_mfma_f32_16x16x32_bf16 v[124:127], v[64:67], v[84:87], v[124:127]
  v_mfma_f32_16x16x32_bf16 v[140:143], v[68:71], v[84:87], v[140:143]
  s_waitcnt lgkmcnt(0)
  v_mfma_f32_16x16x32_bf16 v[112:115], v[40:43], v[48:51], v[112:115]
  ds_read_b128 v[64:67], v14 offset:0
  v_mfma_f32_16x16x32_bf16 v[128:131], v[44:47], v[48:51], v[128:131]
  ds_read_b128 v[68:71], v14 offset:2048
  v_mfma_f32_16x16x32_bf16 v[116:119], v[40:43], v[52:55], v[116:119]
  ds_read_b128 v[72:75], v20 offset:16384
  v_mfma_f32_16x16x32_bf16 v[132:135], v[44:47], v[52:55], v[132:135]
  ds_read_b128 v[76:79], v20 offset:18432
  v_mfma_f32_16x16x32_bf16 v[120:123], v[40:43], v[56:59], v[120:123]
  ds_read_b128 v[80:83], v20 offset:20480
  v_mfma_f32_16x16x32_bf16 v[136:139], v[44:47], v[56:59], v[136:139]
  ds_read_b128 v[84:87], v20 offset:22528
  v_mfma_f32_16x16x32_bf16 v[124:127], v[40:43], v[60:63], v[124:127]
  v_mfma_f32_16x16x32_bf16 v[140:143], v[44:47], v[60:63], v[140:143]
  s_waitcnt lgkmcnt(0)
  s_barrier
  v_mfma_f32_16x16x32_bf16 v[112:115], v[64:67], v[72:75], v[112:115]
  ds_read_b128 v[40:43], v11 offset:32768
  v_mfma_f32_16x16x32_bf16 v[128:131], v[68:71], v[72:75], v[128:131]
  ds_read_b128 v[44:47], v11 offset:34816
  v_mfma_f32_16x16x32_bf16 v[116:119], v[64:67], v[76:79], v[116:119]
  ds_read_b128 v[48:51], v17 offset:49152
  v_mfma_f32_16x16x32_bf16 v[132:135], v[68:71], v[76:79], v[132:135]
  ds_read_b128 v[52:55], v17 offset:51200
  v_mfma_f32_16x16x32_bf16 v[120:123], v[64:67], v[80:83], v[120:123]
  ds_read_b128 v[56:59], v17 offset:53248
  v_mfma_f32_16x16x32_bf16 v[136:139], v[68:71], v[80:83], v[136:139]
  ds_read_b128 v[60:63], v17 offset:55296
  v_mfma_f32_16x16x32_bf16 v[124:127], v[64:67], v[84:87], v[124:127]
  v_mfma_f32_16x16x32_bf16 v[140:143], v[68:71], v[84:87], v[140:143]
  s_waitcnt lgkmcnt(0)
  v_mfma_f32_16x16x32_bf16 v[112:115], v[40:43], v[48:51], v[112:115]
  ds_read_b128 v[64:67], v14 offset:32768
  v_mfma_f32_16x16x32_bf16 v[128:131], v[44:47], v[48:51], v[128:131]
  ds_read_b128 v[68:71], v14 offset:34816
  v_mfma_f32_16x16x32_bf16 v[116:119], v[40:43], v[52:55], v[116:119]
  ds_read_b128 v[72:75], v20 offset:49152
  v_mfma_f32_16x16x32_bf16 v[132:135], v[44:47], v[52:55], v[132:135]
  ds_read_b128 v[76:79], v20 offset:51200
  v_mfma_f32_16x16x32_bf16 v[120:123], v[40:43], v[56:59], v[120:123]
  ds_read_b128 v[80:83], v20 offset:53248
  v_mfma_f32_16x16x32_bf16 v[136:139], v[44:47], v[56:59], v[136:139]
  ds_read_b128 v[84:87], v20 offset:55296
  v_mfma_f32_16x16x32_bf16 v[124:127], v[40:43], v[60:63], v[124:127]
  v_mfma_f32_16x16x32_bf16 v[140:143], v[44:47], v[60:63], v[140:143]
  s_waitcnt lgkmcnt(0)
  s_barrier
  v_mfma_f32_16x16x32_bf16 v[112:115], v[64:67], v[72:75], v[112:115]
  ds_read_b128 v[40:43], v12 offset:0
  v_mfma_f32_16x16x32_bf16 v[128:131], v[68:71], v[72:75], v[128:131]
  ds_read_b128 v[44:47], v12 offset:2048
  v_mfma_f32_16x16x32_bf16 v[116:119], v[64:67], v[76:79], v[116:119]
  ds_read_b128 v[48:51], v18 offset:16384
  v_mfma_f32_16x16x32_bf16 v[132:135], v[68:71], v[76:79], v[132:135]
  ds_read_b128 v[52:55], v18 offset:18432
  v_mfma_f32_16x16x32_bf16 v[120:123], v[64:67], v[80:83], v[120:123]
  ds_read_b128 v[56:59], v18 offset:20480
  v_mfma_f32_16x16x32_bf16 v[136:139], v[68:71], v[80:83], v[136:139]
  ds_read_b128 v[60:63], v18 offset:22528
  v_mfma_f32_16x16x32_bf16 v[124:127], v[64:67], v[84:87], v[124:127]
  v_mfma_f32_16x16x32_bf16 v[140:143], v[68:71], v[84:87], v[140:143]
  s_waitcnt lgkmcnt(0)
  v_mfma_f32_16x16x32_bf16 v[112:115], v[40:43], v[48:51], v[112:115]
  ds_read_b128 v[64:67], v15 offset:0
  v_mfma_f32_16x16x32_bf16 v[128:131], v[44:47], v[48:51], v[128:131]
  ds_read_b128 v[68:71], v15 offset:2048
  v_mfma_f32_16x16x32_bf16 v[116:119], v[40:43], v[52:55], v[116:119]
  ds_read_b128 v[72:75], v21 offset:16384
  v_mfma_f32_16x16x32_bf16 v[132:135], v[44:47], v[52:55], v[132:135]
  ds_read_b128 v[76:79], v21 offset:18432
  v_mfma_f32_16x16x32_bf16 v[120:123], v[40:43], v[56:59], v[120:123]
  ds_read_b128 v[80:83], v21 offset:20480
  v_mfma_f32_16x16x32_bf16 v[136:139], v[44:47], v[56:59], v[136:139]
  ds_read_b128 v[84:87], v21 offset:22528
  v_mfma_f32_16x16x32_bf16 v[124:127], v[40:43], v[60:63], v[124:127]
  v_mfma_f32_16x16x32_bf16 v[140:143], v[44:47], v[60:63], v[140:143]
  s_waitcnt lgkmcnt(0)
  s_mov_b32 s69, 0
L_sp_21:
  s_waitcnt vmcnt(0)
  v_cmp_eq_u32 vcc, 0, v38
  s_nop 1
  s_cbranch_vccz L_ok_22
  s_mov_b64 exec, vcc
  s_add_u32 s69, s69, 1
  s_cmp_ge_u32 s69, 0x40000
  s_cbranch_scc1 L_ok_22
  s_sleep 1
  buffer_load_dword v38, v37, s[60:63], 0 offen sc1
  s_branch L_sp_21
L_ok_22:
  s_mov_b64 exec, -1
  v_readfirstlane_b32 s68, v38
  s_barrier
  v_mfma_f32_16x16x32_bf16 v[112:115], v[64:67], v[72:75], v[112:115]
  ds_read_b128 v[40:43], v10 offset:0
  v_mfma_f32_16x16x32_bf16 v[128:131], v[68:71], v[72:75], v[128:131]
  ds_read_b128 v[44:47], v10 offset:2048
  v_mfma_f32_16x16x32_bf16 v[116:119], v[64:67], v[76:79], v[116:119]
  ds_read_b128 v[48:51], v16 offset:16384
  v_mfma_f32_16x16x32_bf16 v[132:135], v[68:71], v[76:79], v[132:135]
  ds_read_b128 v[52:55], v16 offset:18432
  v_mfma_f32_16x16x32_bf16 v[120:123], v[64:67], v[80:83], v[120:123]
  ds_read_b128 v[56:59], v16 offset:20480
  v_mfma_f32_16x16x32_bf16 v[136:139], v[68:71], v[80:83], v[136:139]
  ds_read_b128 v[60:63], v16 offset:22528
  v_mfma_f32_16x16x32_bf16 v[124:127], v[64:67], v[84:87], v[124:127]
  v_mfma_f32_16x16x32_bf16 v[140:143], v[68:71], v[84:87], v[140:143]
  s_waitcnt lgkmcnt(0)
  v_mfma_f32_16x16x32_bf16 v[112:115], v[40:43], v[48:51], v[112:115]
  ds_read_b128 v[64:67], v13 offset:0
  v_mfma_f32_16x16x32_bf16 v[128:131], v[44:47], v[48:51], v[128:131]
  ds_read_b128 v[68:71], v13 offset:2048
  v_mfma_f32_16x16x32_bf16 v[116:119], v[40:43], v[52:55], v[116:119]
  ds_read_b128 v[72:75], v19 offset:16384
  v_mfma_f32_16x16x32_bf16 v[132:135], v[44:47], v[52:55], v[132:135]
  ds_read_b128 v[76:79], v19 offset:18432
  v_mfma_f32_16x16x32_bf16 v[120:123], v[40:43], v[56:59], v[120:123]
  ds_read_b128 v[80:83], v19 offset:20480
  v_mfma_f32_16x16x32_bf16 v[136:139], v[44:47], v[56:59], v[136:139]
  ds_read_b128 v[84:87], v19 offset:22528
  v_mfma_f32_16x16x32_bf16 v[124:127], v[40:43], v[60:63], v[124:127]
  v_mfma_f32_16x16x32_bf16 v[140:143], v[44:47], v[60:63], v[140:143]
  s_waitcnt lgkmcnt(0)
  s_barrier
  v_mfma_f32_16x16x32_bf16 v[112:115], v[64:67], v[72:75], v[112:115]
  ds_read_b128 v[40:43], v10 offset:32768
  v_mfma_f32_16x16x32_bf16 v[128:131], v[68:71], v[72:75], v[128:131]
  ds_read_b128 v[44:47], v10 offset:34816
  v_mfma_f32_16x16x32_bf16 v[116:119], v[64:67], v[76:79], v[116:119]
  ds_read_b128 v[48:51], v16 offset:49152
  v_mfma_f32_16x16x32_bf16 v[132:135], v[68:71], v[76:79], v[132:135]
  ds_read_b128 v[52:55], v16 offset:51200
  v_mfma_f32_16x16x32_bf16 v[120:123], v[64:67], v[80:83], v[120:123]
  ds_read_b128 v[56:59], v16 offset:53248
  v_mfma_f32_16x16x32_bf16 v[136:139], v[68:71], v[80:83], v[136:139]
  ds_read_b128 v[60:63], v16 offset:55296
  v_mfma_f32_16x16x32_bf16 v[124:127], v[64:67], v[84:87], v[124:127]
  v_mfma_f32_16x16x32_bf16 v[140:143], v[68:71], v[84:87], v[140:143]
  s_waitcnt lgkmcnt(0)
  v_mfma_f32_16x16x32_bf16 v[112:115], v[40:43], v[48:51], v[112:115]
  ds_read_b128 v[64:67], v13 offset:32768
  v_mfma_f32_16x16x32_bf16 v[128:131], v[44:47], v[48:51], v[128:131]
  ds_read_b128 v[68:71], v13 offset:34816
  v_mfma_f32_16x16x32_bf16 v[116:119], v[40:43], v[52:55], v[116:119]
  ds_read_b128 v[72:75], v19 offset:49152
  v_mfma_f32_16x16x32_bf16 v[132:135], v[44:47], v[52:55], v[132:135]
  ds_read_b128 v[76:79], v19 offset:51200
  v_mfma_f32_16x16x32_bf16 v[120:123], v[40:43], v[56:59], v[120:123]
  ds_read_b128 v[80:83], v19 offset:53248
  v_mfma_f32_16x16x32_bf16 v[136:139], v[44:47], v[56:59], v[136:139]
  ds_read_b128 v[84:87], v19 offset:55296
  v_mfma_f32_16x16x32_bf16 v[124:127], v[40:43], v[60:63], v[124:127]
  v_mfma_f32_16x16x32_bf16 v[140:143], v[44:47], v[60:63], v[140:143]
  s_waitcnt lgkmcnt(0)
  s_barrier
  v_mfma_f32_16x16x32_bf16 v[112:115], v[64:67], v[72:75], v[112:115]
  v_mfma_f32_16x16x32_bf16 v[128:131], v[68:71], v[72:75], v[128:131]
  v_mfma_f32_16x16x32_bf16 v[116:119], v[64:67], v[76:79], v[116:119]
  v_mfma_f32_16x16x32_bf16 v[132:135], v[68:71], v[76:79], v[132:135]
  v_mfma_f32_16x16x32_bf16 v[120:123], v[64:67], v[80:83], v[120:123]
  v_mfma_f32_16x16x32_bf16 v[136:139], v[68:71], v[80:83], v[136:139]
  v_mfma_f32_16x16x32_bf16 v[124:127], v[64:67], v[84:87], v[124:127]
  v_mfma_f32_16x16x32_bf16 v[140:143], v[68:71], v[84:87], v[140:143]
  s_branch L_abj_20
L_ab1_19:
  ds_read_b128 v[40:43], v10 offset:0
  ds_read_b128 v[44:47], v10 offset:2048
  ds_read_b128 v[48:51], v16 offset:24576
  ds_read_b128 v[52:55], v16 offset:26624
  ds_read_b128 v[56:59], v16 offset:28672
  s_waitcnt lgkmcnt(0)
  v_mfma_f32_16x16x32_bf16 v[112:115], v[40:43], v[48:51], 0
  ds_read_b128 v[64:67], v13 offset:0
  v_mfma_f32_16x16x32_bf16 v[128:131], v[44:47], v[48:51], 0
  ds_read_b128 v[68:71], v13 offset:2048
  v_mfma_f32_16x16x32_bf16 v[116:119], v[40:43], v[52:55], 0
  ds_read_b128 v[72:75], v19 offset:24576
  v_mfma_f32_16x16x32_bf16 v[132:135], v[44:47], v[52:55], 0
  ds_read_b128 v[76:79], v19 offset:26624
  v_mfma_f32_16x16x32_bf16 v[120:123], v[40:43], v[56:59], 0
  ds_read_b128 v[80:83], v19 offset:28672
  v_mfma_f32_16x16x32_bf16 v[136:139], v[44:47], v[56:59], 0
  s_waitcnt lgkmcnt(0)
  s_barrier
  v_mfma_f32_16x16x32_bf16 v[112:115], v[64:67], v[72:75], v[112:115]
  ds_read_b128 v[40:43], v10 offset:32768
  v_mfma_f32_16x16x32_bf16 v[128:131], v[68:71], v[72:75], v[128:131]
  ds_read_b128 v[44:47], v10 offset:34816
  v_mfma_f32_16x16x32_bf16 v[116:119], v[64:67], v[76:79], v[116:119]
  ds_read_b128 v[48:51], v16 offset:57344
  v_mfma_f32_16x16x32_bf16 v[132:135], v[68:71], v[76:79], v[132:135]
  ds_read_b128 v[52:55], v16 offset:59392
  v_mfma_f32_16x16x32_bf16 v[120:123], v[64:67], v[80:83], v[120:123]
  ds_read_b128 v[56:59], v16 offset:61440
  v_mfma_f32_16x16x32_bf16 v[136:139], v[68:71], v[80:83], v[136:139]
  s_waitcnt lgkmcnt(0)
  v_mfma_f32_16x16x32_bf16 v[112:115], v[40:43], v[48:51], v[112:115]
  ds_read_b128 v[64:67], v13 offset:32768
  v_mfma_f32_16x16x32_bf16 v[128:131], v[44:47], v[48:51], v[128:131]
  ds_read_b128 v[68:71], v13 offset:34816
  v_mfma_f32_16x16x32_bf16 v[116:119], v[40:43], v[52:55], v[116:119]
  ds_read_b128 v[72:75], v19 offset:57344
  v_mfma_f32_16x16x32_bf16 v[132:135], v[44:47], v[52:55], v[132:135]
  ds_read_b128 v[76:79], v19 offset:59392
  v_mfma_f32_16x16x32_bf16 v[120:123], v[40:43], v[56:59], v[120:123]
  ds_read_b128 v[80:83], v19 offset:61440
  v_mfma_f32_16x16x32_bf16 v[136:139], v[44:47], v[56:59], v[136:139]
  s_waitcnt lgkmcnt(0)
  s_barrier
  v_mfma_f32_16x16x32_bf16 v[112:115], v[64:67], v[72:75], v[112:115]
  ds_read_b128 v[40:43], v11 offset:0
  v_mfma_f32_16x16x32_bf16 v[128:131], v[68:71], v[72:75], v[128:131]
  ds_read_b128 v[44:47], v11 offset:2048
  v_mfma_f32_16x16x32_bf16 v[116:119], v[64:67], v[76:79], v[116:119]
  ds_read_b128 v[48:51], v17 offset:24576
  v_mfma_f32_16x16x32_bf16 v[132:135], v[68:71], v[76:79], v[132:135]
  ds_read_b128 v[52:55], v17 offset:26624
  v_mfma_f32_16x16x32_bf16 v[120:123], v[64:67], v[80:83], v[120:123]
  ds_read_b128 v[56:59], v17 offset:28672
  v_mfma_f32_16x16x32_bf16 v[136:139], v[68:71], v[80:83], v[136:139]
  s_waitcnt lgkmcnt(0)
  v_mfma_f32_16x16x32_bf16 v[112:115], v[40:43], v[48:51], v[112:115]
  ds_read_b128 v[64:67], v14 offset:0
  v_mfma_f32_16x16x32_bf16 v[128:131], v[44:47], v[48:51], v[128:131]
  ds_read_b128 v[68:71], v14 offset:2048
  v_mfma_f32_16x16x32_bf16 v[116:119], v[40:43], v[52:55], v[116:119]
  ds_read_b128 v[72:75], v20 offset:24576
  v_mfma_f32_16x16x32_bf16 v[132:135], v[44:47], v[52:55], v[132:135]
  ds_read_b128 v[76:79], v20 offset:26624
  v_mfma_f32_16x16x32_bf16 v[120:123], v[40:43], v[56:59], v[120:123]
  ds_read_b128 v[80:83], v20 offset:28672
  v_mfma_f32_16x16x32_bf16 v[136:139], v[44:47], v[56:59], v[136:139]
  s_waitcnt lgkmcnt(0)
  s_barrier
  v_mfma_f32_16x16x32_bf16 v[112:115], v[64:67], v[72:75], v[112:115]
  ds_read_b128 v[40:43], v11 offset:32768
  v_mfma_f32_16x16x32_bf16 v[128:131], v[68:71], v[72:75], v[128:131]
  ds_read_b128 v[44:47], v11 offset:34816
  v_mfma_f32_16x16x32_bf16 v[116:119], v[64:67], v[76:79], v[116:119]
  ds_read_b128 v[48:51], v17 offset:57344
  v_mfma_f32_16x16x32_bf16 v[132:135], v[68:71], v[76:79], v[132:135]
  ds_read_b128 v[52:55], v17 offset:59392
  v_mfma_f32_16x16x32_bf16 v[120:123], v[64:67], v[80:83], v[120:123]
  ds_read_b128 v[56:59], v17 offset:61440
  v_mfma_f32_16x16x32_bf16 v[136:139], v[68:71], v[80:83], v[136:139]
  s_waitcnt lgkmcnt(0)
  v_mfma_f32_16x16x32_bf16 v[112:115], v[40:43], v[48:51], v[112:115]
  ds_read_b128 v[64:67], v14 offset:32768
  v_mfma_f32_16x16x32_bf16 v[128:131], v[44:47], v[48:51], v[128:131]
  ds_read_b128 v[68:71], v14 offset:34816
  v_mfma_f32_16x16x32_bf16 v[116:119], v[40:43], v[52:55], v[116:119]
  ds_read_b128 v[72:75], v20 offset:57344
  v_mfma_f32_16x16x32_bf16 v[132:135], v[44:47], v[52:55], v[132:135]
  ds_read_b128 v[76:79], v20 offset:59392
  v_mfma_f32_16x16x32_bf16 v[120:123], v[40:43], v[56:59], v[120:123]
  ds_read_b128 v[80:83], v20 offset:61440
  v_mfma_f32_16x16x32_bf16 v[136:139], v[44:47], v[56:59], v[136:139]
  s_waitcnt lgkmcnt(0)
  s_barrier
  v_mfma_f32_16x16x32_bf16 v[112:115], v[64:67], v[72:75], v[112:115]
  ds_read_b128 v[40:43], v12 offset:0
  v_mfma_f32_16x16x32_bf16 v[128:131], v[68:71], v[72:75], v[128:131]
  ds_read_b128 v[44:47], v12 offset:2048
  v_mfma_f32_16x16x32_bf16 v[116:119], v[64:67], v[76:79], v[116:119]
  ds_read_b128 v[48:51], v18 offset:24576
  v_mfma_f32_16x16x32_bf16 v[132:135], v[68:71], v[76:79], v[132:135]
  ds_read_b128 v[52:55], v18 offset:26624
  v_mfma_f32_16x16x32_bf16 v[120:123], v[64:67], v[80:83], v[120:123]
  ds_read_b128 v[56:59], v18 offset:28672
  v_mfma_f32_16x16x32_bf16 v[136:139], v[68:71], v[80:83], v[136:139]
  s_waitcnt lgkmcnt(0)
  v_mfma_f32_16x16x32_bf16 v[112:115], v[40:43], v[48:51], v[112:115]
  ds_read_b128 v[64:67], v15 offset:0
  v_mfma_f32_16x16x32_bf16 v[128:131], v[44:47], v[48:51], v[128:131]
  ds_read_b128 v[68:71], v15 offset:2048
  v_mfma_f32_16x16x32_bf16 v[116:119], v[40:43], v[52:55], v[116:119]
  ds_read_b128 v[72:75], v21 offset:24576
  v_mfma_f32_16x16x32_bf16 v[132:135], v[44:47], v[52:55], v[132:135]
  ds_read_b128 v[76:79], v21 offset:26624
  v_mfma_f32_16x16x32_bf16 v[120:123], v[40:43], v[56:59], v[120:123]
  ds_read_b128 v[80:83], v21 offset:28672
  v_mfma_f32_16x16x32_bf16 v[136:139], v[44:47], v[56:59], v[136:139]
  s_waitcnt lgkmcnt(0)
  s_mov_b32 s69, 0
L_sp_23:
  s_waitcnt vmcnt(0)
  v_cmp_eq_u32 vcc, 0, v38
  s_nop 1
  s_cbranch_vccz L_ok_24
  s_mov_b64 exec, vcc
  s_add_u32 s69, s69, 1
  s_cmp_ge_u32 s69, 0x40000
  s_cbranch_scc1 L_ok_24
  s_sleep 1
  buffer_load_dword v38, v37, s[60:63], 0 offen sc1
  s_branch L_sp_23
L_ok_24:
  s_mov_b64 exec, -1
  v_readfirstlane_b32 s68, v38
  s_barrier
  v_mfma_f32_16x16x32_bf16 v[112:115], v[64:67], v[72:75], v[112:115]
  ds_read_b128 v[40:43], v10 offset:0
  v_mfma_f32_16x16x32_bf16 v[128:131], v[68:71], v[72:75], v[128:131]
  ds_read_b128 v[44:47], v10 offset:2048
  v_mfma_f32_16x16x32_bf16 v[116:119], v[64:67], v[76:79], v[116:119]
  ds_read_b128 v[48:51], v16 offset:24576
  v_mfma_f32_16x16x32_bf16 v[132:135], v[68:71], v[76:79], v[132:135]
  ds_read_b128 v[52:55], v16 offset:26624
  v_mfma_f32_16x16x32_bf16 v[120:123], v[64:67], v[80:83], v[120:123]
  ds_read_b128 v[56:59], v16 offset:28672
  v_mfma_f32_16x16x32_bf16 v[136:139], v[68:71], v[80:83], v[136:139]
  s_waitcnt lgkmcnt(0)
  v_mfma_f32_16x16x32_bf16 v[112:115], v[40:43], v[48:51], v[112:115]
  ds_read_b128 v[64:67], v13 offset:0
  v_mfma_f32_16x16x32_bf16 v[128:131], v[44:47], v[48:51], v[128:131]
  ds_read_b128 v[68:71], v13 offset:2048
  v_mfma_f32_16x16x32_bf16 v[116:119], v[40:43], v[52:55], v[116:119]
  ds_read_b128 v[72:75], v19 offset:24576
  v_mfma_f32_16x16x32_bf16 v[132:135], v[44:47], v[52:55], v[132:135]
  ds_read_b128 v[76:79], v19 offset:26624
  v_mfma_f32_16x16x32_bf16 v[120:123], v[40:43], v[56:59], v[120:123]
  ds_read_b128 v[80:83], v19 offset:28672
  v_mfma_f32_16x16x32_bf16 v[136:139], v[44:47], v[56:59], v[136:139]
  s_waitcnt lgkmcnt(0)
  s_barrier
  v_mfma_f32_16x16x32_bf16 v[112:115], v[64:67], v[72:75], v[112:115]
  ds_read_b128 v[40:43], v10 offset:32768
  v_mfma_f32_16x16x32_bf16 v[128:131], v[68:71], v[72:75], v[128:131]
  ds_read_b128 v[44:47], v10 offset:34816
  v_mfma_f32_16x16x32_bf16 v[116:119], v[64:67], v[76:79], v[116:119]
  ds_read_b128 v[48:51], v16 offset:57344
  v_mfma_f32_16x16x32_bf16 v[132:135], v[68:71], v[76:79], v[132:135]
  ds_read_b128 v[52:55], v16 offset:59392
  v_mfma_f32_16x16x32_bf16 v[120:123], v[64:67], v[80:83], v[120:123]
  ds_read_b128 v[56:59], v16 offset:61440
  v_mfma_f32_16x16x32_bf16 v[136:139], v[68:71], v[80:83], v[136:139]
  s_waitcnt lgkmcnt(0)
  v_mfma_f32_16x16x32_bf16 v[112:115], v[40:43], v[48:51], v[112:115]
  ds_read_b128 v[64:67], v13 offset:32768
  v_mfma_f32_16x16x32_bf16 v[128:131], v[44:47], v[48:51], v[128:131]
  ds_read_b128 v[68:71], v13 offset:34816
  v_mfma_f32_16x16x32_bf16 v[116:119], v[40:43], v[52:55], v[116:119]
  ds_read_b128 v[72:75], v19 offset:57344
  v_mfma_f32_16x16x32_bf16 v[132:135], v[44:47], v[52:55], v[132:135]
  ds_read_b128 v[76:79], v19 offset:59392
  v_mfma_f32_16x16x32_bf16 v[120:123], v[40:43], v[56:59], v[120:123]
  ds_read_b128 v[80:83], v19 offset:61440
  v_mfma_f32_16x16x32_bf16 v[136:139], v[44:47], v[56:59], v[136:139]
  s_waitcnt lgkmcnt(0)
  s_barrier
  v_mfma_f32_16x16x32_bf16 v[112:115], v[64:67], v[72:75], v[112:115]
  v_mfma_f32_16x16x32_bf16 v[128:131], v[68:71], v[72:75], v[128:131]
  v_mfma_f32_16x16x32_bf16 v[116:119], v[64:67], v[76:79], v[116:119]
  v_mfma_f32_16x16x32_bf16 v[132:135], v[68:71], v[76:79], v[132:135]
  v_mfma_f32_16x16x32_bf16 v[120:123], v[64:67], v[80:83], v[120:123]
  v_mfma_f32_16x16x32_bf16 v[136:139], v[68:71], v[80:83], v[136:139]
L_abj_20:
  s_nop 2
  v_cvt_pk_bf16_f32 v112, v112, v113
  v_cvt_pk_bf16_f32 v113, v114, v115
  v_cvt_pk_bf16_f32 v114, v128, v129
  v_cvt_pk_bf16_f32 v115, v130, v131
  v_xor_b32 v112, s77, v112
  v_xor_b32 v113, s77, v113
  v_xor_b32 v114, s77, v114
  v_xor_b32 v115, s77, v115
  buffer_store_dwordx4 v[112:115], v5, s[52:55], s76 offen offset:0 sc1
  v_cvt_pk_bf16_f32 v116, v116, v117
  v_cvt_pk_bf16_f32 v117, v118, v119
  v_cvt_pk_bf16_f32 v118, v132, v133
  v_cvt_pk_bf16_f32 v119, v134, v135
  v_xor_b32 v116, s77, v116
  v_xor_b32 v117, s77, v117
  v_xor_b32 v118, s77, v118
  v_xor_b32 v119, s77, v119
  buffer_store_dwordx4 v[116:119], v5, s[52:55], s76 offen offset:1024 sc1
  v_cvt_pk_bf16_f32 v120, v120, v121
  v_cvt_pk_bf16_f32 v121, v122, v123
  v_cvt_pk_bf16_f32 v122, v136, v137
  v_cvt_pk_bf16_f32 v123, v138, v139
  v_xor_b32 v120, s77, v120
  v_xor_b32 v121, s77, v121
  v_xor_b32 v122, s77, v122
  v_xor_b32 v123, s77, v123
  buffer_store_dwordx4 v[120:123], v5, s[52:55], s76 offen offset:2048 sc1
  v_cvt_pk_bf16_f32 v124, v124, v125
  v_cvt_pk_bf16_f32 v125, v126, v127
  v_cvt_pk_bf16_f32 v126, v140, v141
  v_cvt_pk_bf16_f32 v127, v142, v143
  v_xor_b32 v124, s77, v124
  v_xor_b32 v125, s77, v125
  v_xor_b32 v126, s77, v126
  v_xor_b32 v127, s77, v127
  buffer_store_dwordx4 v[124:127], v5, s[52:55], s82 offen offset:3072 sc1
  s_lshl_b32 s70, s64, 12
  v_add_u32 v10, s70, v16
  v_add_u32 v13, s70, v19
  v_add_u32 v11, 0x10000, v10
  v_add_u32 v12, 0x20000, v10
  v_add_u32 v14, 0x10000, v13
  v_add_u32 v15, 0x20000, v13
  v_lshrrev_b32 v4, 2, v3
  v_lshl_add_u32 v4, v2, 3, v4
  v_mul_u32_u24 v4, 192, v4
  v_and_b32 v6, 1, v2
  v_lshl_add_u32 v4, v6, 3, v4
  v_and_b32 v6, 3, v3
  v_lshl_add_u32 v22, v6, 4, v4
  v_add_u32 v23, 0x10000, v22
  v_add_u32 v24, 0x20000, v22
  s_waitcnt vmcnt(0)
  s_add_u32 s70, s26, 0
  v_mov_b32 v36, s68
  s_mov_b64 exec, 1
  buffer_store_dword v36, v37, s[52:55], s70 offen sc1
  s_mov_b64 exec, -1
  s_barrier
  ds_read_b128 v[40:43], v11 offset:0
  ds_read_b128 v[44:47], v11 offset:2048
  ds_read_b64_tr_b16 v[48:49], v23 offset:16384
  ds_read_b64_tr_b16 v[50:51], v23 offset:17152
  ds_read_b64_tr_b16 v[52:53], v23 offset:16392
  ds_read_b64_tr_b16 v[54:55], v23 offset:17160
  ds_read_b64_tr_b16 v[56:57], v23 offset:16440
  ds_read_b64_tr_b16 v[58:59], v23 offset:17208
  ds_read_b64_tr_b16 v[60:61], v23 offset:16448
  ds_read_b64_tr_b16 v[62:63], v23 offset:17216
  ds_read_b64_tr_b16 v[64:65], v23 offset:16496
  ds_read_b64_tr_b16 v[66:67], v23 offset:17264
  ds_read_b64_tr_b16 v[68:69], v23 offset:16504
  ds_read_b64_tr_b16 v[70:71], v23 offset:17272
  s_waitcnt lgkmcnt(0)
  v_mfma_f32_16x16x32_bf16 v[144:147], v[48:51], v[40:43], 0
  ds_read_b128 v[72:75], v14 offset:0
  ds_read_b128 v[76:79], v14 offset:2048
  v_mfma_f32_16x16x32_bf16 v[152:155], v[48:51], v[44:47], 0
  ds_read_b64_tr_b16 v[80:81], v23 offset:22528
  ds_read_b64_tr_b16 v[82:83], v23 offset:23296
  v_mfma_f32_16x16x32_bf16 v[148:151], v[52:55], v[40:43], 0
  ds_read_b64_tr_b16 v[84:85], v23 offset:22536
  ds_read_b64_tr_b16 v[86:87], v23 offset:23304
  v_mfma_f32_16x16x32_bf16 v[156:159], v[52:55], v[44:47], 0
  ds_read_b64_tr_b16 v[88:89], v23 offset:22584
  ds_read_b64_tr_b16 v[90:91], v23 offset:23352
  v_mfma_f32_16x16x32_bf16 v[160:163], v[56:59], v[40:43], 0
  ds_read_b64_tr_b16 v[92:93], v23 offset:22592
  ds_read_b64_tr_b16 v[94:95], v23 offset:23360
  v_mfma_f32_16x16x32_bf16 v[168:171], v[56:59], v[44:47], 0
  ds_read_b64_tr_b16 v[96:97], v23 offset:22640
  ds_read_b64_tr_b16 v[98:99], v23 offset:23408
  v_mfma_f32_16x16x32_bf16 v[164:167], v[60:63], v[40:43], 0
  ds_read_b64_tr_b16 v[100:101], v23 offset:22648
  ds_read_b64_tr_b16 v[102:103], v23 offset:23416
  v_mfma_f32_16x16x32_bf16 v[172:175], v[60:63], v[44:47], 0
  v_mfma_f32_16x16x32_bf16 v[176:179], v[64:67], v[40:43], 0
  v_mfma_f32_16x16x32_bf16 v[184:187], v[64:67], v[44:47], 0
  v_mfma_f32_16x16x32_bf16 v[180:183], v[68:71], v[40:43], 0
  v_mfma_f32_16x16x32_bf16 v[188:191], v[68:71], v[44:47], 0
  s_waitcnt lgkmcnt(0)
  s_barrier
  v_mfma_f32_16x16x32_bf16 v[144:147], v[80:83], v[72:75], v[144:147]
  ds_read_b128 v[40:43], v11 offset:32768
  ds_read_b128 v[44:47], v11 offset:34816
  v_mfma_f32_16x16x32_bf16 v[152:155], v[80:83], v[76:79], v[152:155]
  ds_read_b64_tr_b16 v[48:49], v23 offset:49152
  ds_read_b64_tr_b16 v[50:51], v23 offset:49920
  v_mfma_f32_16x16x32_bf16 v[148:151], v[84:87], v[72:75], v[148:151]
  ds_read_b64_tr_b16 v[52:53], v23 offset:49160
  ds_read_b64_tr_b16 v[54:55], v23 offset:49928
  v_mfma_f32_16x16x32_bf16 v[156:159], v[84:87], v[76:79], v[156:159]
  ds_read_b64_tr_b16 v[56:57], v23 offset:49208
  ds_read_b64_tr_b16 v[58:59], v23 offset:49976
  v_mfma_f32_16x16x32_bf16 v[160:163], v[88:91], v[72:75], v[160:163]
  ds_read_b64_tr_b16 v[60:61], v23 offset:49216
  ds_read_b64_tr_b16 v[62:63], v23 offset:49984
  v_mfma_f32_16x16x32_bf16 v[168:171], v[88:91], v[76:79], v[168:171]
  ds_read_b64_tr_b16 v[64:65], v23 offset:49264
  ds_read_b64_tr_b16 v[66:67], v23 offset:50032
  v_mfma_f32_16x16x32_bf16 v[164:167], v[92:95], v[72:75], v[164:167]
  ds_read_b64_tr_b16 v[68:69], v23 offset:49272
  ds_read_b64_tr_b16 v[70:71], v23 offset:50040
  v_mfma_f32_16x16x32_bf16 v[172:175], v[92:95], v[76:79], v[172:175]
  v_mfma_f32_16x16x32_bf16 v[176:179], v[96:99], v[72:75], v[176:179]
  v_mfma_f32_16x16x32_bf16 v[184:187], v[96:99], v[76:79], v[184:187]
  v_mfma_f32_16x16x32_bf16 v[180:183], v[100:103], v[72:75], v[180:183]
  v_mfma_f32_16x16x32_bf16 v[188:191], v[100:103], v[76:79], v[188:191]
  s_waitcnt lgkmcnt(0)
  v_mfma_f32_16x16x32_bf16 v[144:147], v[48:51], v[40:43], v[144:147]
  ds_read_b128 v[72:75], v14 offset:32768
  ds_read_b128 v[76:79], v14 offset:34816
  v_mfma_f32_16x16x32_bf16 v[152:155], v[48:51], v[44:47], v[152:155]
  ds_read_b64_tr_b16 v[80:81], v23 offset:55296
  ds_read_b64_tr_b16 v[82:83], v23 offset:56064
  v_mfma_f32_16x16x32_bf16 v[148:151], v[52:55], v[40:43], v[148:151]
  ds_read_b64_tr_b16 v[84:85], v23 offset:55304
  ds_read_b64_tr_b16 v[86:87], v23 offset:56072
  v_mfma_f32_16x16x32_bf16 v[156:159], v[52:55], v[44:47], v[156:159]
  ds_read_b64_tr_b16 v[88:89], v23 offset:55352
  ds_read_b64_tr_b16 v[90:91], v23 offset:56120
  v_mfma_f32_16x16x32_bf16 v[160:163], v[56:59], v[40:43], v[160:163]
  ds_read_b64_tr_b16 v[92:93], v23 offset:55360
  ds_read_b64_tr_b16 v[94:95], v23 offset:56128
  v_mfma_f32_16x16x32_bf16 v[168:171], v[56:59], v[44:47], v[168:171]
  ds_read_b64_tr_b16 v[96:97], v23 offset:55408
  ds_read_b64_tr_b16 v[98:99], v23 offset:56176
  v_mfma_f32_16x16x32_bf16 v[164:167], v[60:63], v[40:43], v[164:167]
  ds_read_b64_tr_b16 v[100:101], v23 offset:55416
  ds_read_b64_tr_b16 v[102:103], v23 offset:56184
  v_mfma_f32_16x16x32_bf16 v[172:175], v[60:63], v[44:47], v[172:175]
  v_mfma_f32_16x16x32_bf16 v[176:179], v[64:67], v[40:43], v[176:179]
  v_mfma_f32_16x16x32_bf16 v[184:187], v[64:67], v[44:47], v[184:187]
  v_mfma_f32_16x16x32_bf16 v[180:183], v[68:71], v[40:43], v[180:183]
  v_mfma_f32_16x16x32_bf16 v[188:191], v[68:71], v[44:47], v[188:191]
  s_waitcnt lgkmcnt(0)
  s_barrier
  v_mfma_f32_16x16x32_bf16 v[144:147], v[80:83], v[72:75], v[144:147]
  ds_read_b128 v[40:43], v12 offset:0
  ds_read_b128 v[44:47], v12 offset:2048
  v_mfma_f32_16x16x32_bf16 v[152:155], v[80:83], v[76:79], v[152:155]
  ds_read_b64_tr_b16 v[48:49], v24 offset:16384
  ds_read_b64_tr_b16 v[50:51], v24 offset:17152
  v_mfma_f32_16x16x32_bf16 v[148:151], v[84:87], v[72:75], v[148:151]
  ds_read_b64_tr_b16 v[52:53], v24 offset:16392
  ds_read_b64_tr_b16 v[54:55], v24 offset:17160
  v_mfma_f32_16x16x32_bf16 v[156:159], v[84:87], v[76:79], v[156:159]
  ds_read_b64_tr_b16 v[56:57], v24 offset:16440
  ds_read_b64_tr_b16 v[58:59], v24 offset:17208
  v_mfma_f32_16x16x32_bf16 v[160:163], v[88:91], v[72:75], v[160:163]
  ds_read_b64_tr_b16 v[60:61], v24 offset:16448
  ds_read_b64_tr_b16 v[62:63], v24 offset:17216
  v_mfma_f32_16x16x32_bf16 v[168:171], v[88:91], v[76:79], v[168:171]
  ds_read_b64_tr_b16 v[64:65], v24 offset:16496
  ds_read_b64_tr_b16 v[66:67], v24 offset:17264
  v_mfma_f32_16x16x32_bf16 v[164:167], v[92:95], v[72:75], v[164:167]
  ds_read_b64_tr_b16 v[68:69], v24 offset:16504
  ds_read_b64_tr_b16 v[70:71], v24 offset:17272
  v_mfma_f32_16x16x32_bf16 v[172:175], v[92:95], v[76:79], v[172:175]
  v_mfma_f32_16x16x32_bf16 v[176:179], v[96:99], v[72:75], v[176:179]
  v_mfma_f32_16x16x32_bf16 v[184:187], v[96:99], v[76:79], v[184:187]
  v_mfma_f32_16x16x32_bf16 v[180:183], v[100:103], v[72:75], v[180:183]
  v_mfma_f32_16x16x32_bf16 v[188:191], v[100:103], v[76:79], v[188:191]
  s_waitcnt lgkmcnt(0)
  v_mfma_f32_16x16x32_bf16 v[144:147], v[48:51], v[40:43], v[144:147]
  ds_read_b128 v[72:75], v15 offset:0
  ds_read_b128 v[76:79], v15 offset:2048
  v_mfma_f32_16x16x32_bf16 v[152:155], v[48:51], v[44:47], v[152:155]
  ds_read_b64_tr_b16 v[80:81], v24 offset:22528
  ds_read_b64_tr_b16 v[82:83], v24 offset:23296
  v_mfma_f32_16x16x32_bf16 v[148:151], v[52:55], v[40:43], v[148:151]
  ds_read_b64_tr_b16 v[84:85], v24 offset:22536
  ds_read_b64_tr_b16 v[86:87], v24 offset:23304
  v_mfma_f32_16x16x32_bf16 v[156:159], v[52:55], v[44:47], v[156:159]
  ds_read_b64_tr_b16 v[88:89], v24 offset:22584
  ds_read_b64_tr_b16 v[90:91], v24 offset:23352
  v_mfma_f32_16x16x32_bf16 v[160:163], v[56:59], v[40:43], v[160:163]
  ds_read_b64_tr_b16 v[92:93], v24 offset:22592
  ds_read_b64_tr_b16 v[94:95], v24 offset:23360
  v_mfma_f32_16x16x32_bf16 v[168:171], v[56:59], v[44:47], v[168:171]
  ds_read_b64_tr_b16 v[96:97], v24 offset:22640
  ds_read_b64_tr_b16 v[98:99], v24 offset:23408
  v_mfma_f32_16x16x32_bf16 v[164:167], v[60:63], v[40:43], v[164:167]
  ds_read_b64_tr_b16 v[100:101], v24 offset:22648
  ds_read_b64_tr_b16 v[102:103], v24 offset:23416
  v_mfma_f32_16x16x32_bf16 v[172:175], v[60:63], v[44:47], v[172:175]
  v_mfma_f32_16x16x32_bf16 v[176:179], v[64:67], v[40:43], v[176:179]
  v_mfma_f32_16x16x32_bf16 v[184:187], v[64:67], v[44:47], v[184:187]
  v_mfma_f32_16x16x32_bf16 v[180:183], v[68:71], v[40:43], v[180:183]
  v_mfma_f32_16x16x32_bf16 v[188:191], v[68:71], v[44:47], v[188:191]
  s_waitcnt lgkmcnt(0)
  s_barrier
  v_mfma_f32_16x16x32_bf16 v[144:147], v[80:83], v[72:75], v[144:147]
  ds_read_b128 v[40:43], v10 offset:0
  ds_read_b128 v[44:47], v10 offset:2048
  v_mfma_f32_16x16x32_bf16 v[152:155], v[80:83], v[76:79], v[152:155]
  ds_read_b64_tr_b16 v[48:49], v22 offset:16384
  ds_read_b64_tr_b16 v[50:51], v22 offset:17152
  v_mfma_f32_16x16x32_bf16 v[148:151], v[84:87], v[72:75], v[148:151]
  ds_read_b64_tr_b16 v[52:53], v22 offset:16392
  ds_read_b64_tr_b16 v[54:55], v22 offset:17160
  v_mfma_f32_16x16x32_bf16 v[156:159], v[84:87], v[76:79], v[156:159]
  ds_read_b64_tr_b16 v[56:57], v22 offset:16440
  ds_read_b64_tr_b16 v[58:59], v22 offset:17208
  v_mfma_f32_16x16x32_bf16 v[160:163], v[88:91], v[72:75], v[160:163]
  ds_read_b64_tr_b16 v[60:61], v22 offset:16448
  ds_read_b64_tr_b16 v[62:63], v22 offset:17216
  v_mfma_f32_16x16x32_bf16 v[168:171], v[88:91], v[76:79], v[168:171]
  ds_read_b64_tr_b16 v[64:65], v22 offset:16496
  ds_read_b64_tr_b16 v[66:67], v22 offset:17264
  v_mfma_f32_16x16x32_bf16 v[164:167], v[92:95], v[72:75], v[164:167]
  ds_read_b64_tr_b16 v[68:69], v22 offset:16504
  ds_read_b64_tr_b16 v[70:71], v22 offset:17272
  v_mfma_f32_16x16x32_bf16 v[172:175], v[92:95], v[76:79], v[172:175]
  v_mfma_f32_16x16x32_bf16 v[176:179], v[96:99], v[72:75], v[176:179]
  v_mfma_f32_16x16x32_bf16 v[184:187], v[96:99], v[76:79], v[184:187]
  v_mfma_f32_16x16x32_bf16 v[180:183], v[100:103], v[72:75], v[180:183]
  v_mfma_f32_16x16x32_bf16 v[188:191], v[100:103], v[76:79], v[188:191]
  s_waitcnt lgkmcnt(0)
  v_mfma_f32_16x16x32_bf16 v[144:147], v[48:51], v[40:43], v[144:147]
  ds_read_b128 v[72:75], v13 offset:0
  ds_read_b128 v[76:79], v13 offset:2048
  v_mfma_f32_16x16x32_bf16 v[152:155], v[48:51], v[44:47], v[152:155]
  ds_read_b64_tr_b16 v[80:81], v22 offset:22528
  ds_read_b64_tr_b16 v[82:83], v22 offset:23296
  v_mfma_f32_16x16x32_bf16 v[148:151], v[52:55], v[40:43], v[148:151]
  ds_read_b64_tr_b16 v[84:85], v22 offset:22536
  ds_read_b64_tr_b16 v[86:87], v22 offset:23304
  v_mfma_f32_16x16x32_bf16 v[156:159], v[52:55], v[44:47], v[156:159]
  ds_read_b64_tr_b16 v[88:89], v22 offset:22584
  ds_read_b64_tr_b16 v[90:91], v22 offset:23352
  v_mfma_f32_16x16x32_bf16 v[160:163], v[56:59], v[40:43], v[160:163]
  ds_read_b64_tr_b16 v[92:93], v22 offset:22592
  ds_read_b64_tr_b16 v[94:95], v22 offset:23360
  v_mfma_f32_16x16x32_bf16 v[168:171], v[56:59], v[44:47], v[168:171]
  ds_read_b64_tr_b16 v[96:97], v22 offset:22640
  ds_read_b64_tr_b16 v[98:99], v22 offset:23408
  v_mfma_f32_16x16x32_bf16 v[164:167], v[60:63], v[40:43], v[164:167]
  ds_read_b64_tr_b16 v[100:101], v22 offset:22648
  ds_read_b64_tr_b16 v[102:103], v22 offset:23416
  v_mfma_f32_16x16x32_bf16 v[172:175], v[60:63], v[44:47], v[172:175]
  v_mfma_f32_16x16x32_bf16 v[176:179], v[64:67], v[40:43], v[176:179]
  v_mfma_f32_16x16x32_bf16 v[184:187], v[64:67], v[44:47], v[184:187]
  v_mfma_f32_16x16x32_bf16 v[180:183], v[68:71], v[40:43], v[180:183]
  v_mfma_f32_16x16x32_bf16 v[188:191], v[68:71], v[44:47], v[188:191]
  s_waitcnt lgkmcnt(0)
  s_barrier
  v_mfma_f32_16x16x32_bf16 v[144:147], v[80:83], v[72:75], v[144:147]
  ds_read_b128 v[40:43], v10 offset:32768
  ds_read_b128 v[44:47], v10 offset:34816
  v_mfma_f32_16x16x32_bf16 v[152:155], v[80:83], v[76:79], v[152:155]
  ds_read_b64_tr_b16 v[48:49], v22 offset:49152
  ds_read_b64_tr_b16 v[50:51], v22 offset:49920
  v_mfma_f32_16x16x32_bf16 v[148:151], v[84:87], v[72:75], v[148:151]
  ds_read_b64_tr_b16 v[52:53], v22 offset:49160
  ds_read_b64_tr_b16 v[54:55], v22 offset:49928
  v_mfma_f32_16x16x32_bf16 v[156:159], v[84:87], v[76:79], v[156:159]
  ds_read_b64_tr_b16 v[56:57], v22 offset:49208
  ds_read_b64_tr_b16 v[58:59], v22 offset:49976
  v_mfma_f32_16x16x32_bf16 v[160:163], v[88:91], v[72:75], v[160:163]
  ds_read_b64_tr_b16 v[60:61], v22 offset:49216
  ds_read_b64_tr_b16 v[62:63], v22 offset:49984
  v_mfma_f32_16x16x32_bf16 v[168:171], v[88:91], v[76:79], v[168:171]
  ds_read_b64_tr_b16 v[64:65], v22 offset:49264
  ds_read_b64_tr_b16 v[66:67], v22 offset:50032
  v_mfma_f32_16x16x32_bf16 v[164:167], v[92:95], v[72:75], v[164:167]
  ds_read_b64_tr_b16 v[68:69], v22 offset:49272
  ds_read_b64_tr_b16 v[70:71], v22 offset:50040
  v_mfma_f32_16x16x32_bf16 v[172:175], v[92:95], v[76:79], v[172:175]
  v_mfma_f32_16x16x32_bf16 v[176:179], v[96:99], v[72:75], v[176:179]
  v_mfma_f32_16x16x32_bf16 v[184:187], v[96:99], v[76:79], v[184:187]
  v_mfma_f32_16x16x32_bf16 v[180:183], v[100:103], v[72:75], v[180:183]
  v_mfma_f32_16x16x32_bf16 v[188:191], v[100:103], v[76:79], v[188:191]
  s_waitcnt lgkmcnt(0)
  v_mfma_f32_16x16x32_bf16 v[144:147], v[48:51], v[40:43], v[144:147]
  ds_read_b128 v[72:75], v13 offset:32768
  ds_read_b128 v[76:79], v13 offset:34816
  v_mfma_f32_16x16x32_bf16 v[152:155], v[48:51], v[44:47], v[152:155]
  ds_read_b64_tr_b16 v[80:81], v22 offset:55296
  ds_read_b64_tr_b16 v[82:83], v22 offset:56064
  v_mfma_f32_16x16x32_bf16 v[148:151], v[52:55], v[40:43], v[148:151]
  ds_read_b64_tr_b16 v[84:85], v22 offset:55304
  ds_read_b64_tr_b16 v[86:87], v22 offset:56072
  v_mfma_f32_16x16x32_bf16 v[156:159], v[52:55], v[44:47], v[156:159]
  ds_read_b64_tr_b16 v[88:89], v22 offset:55352
  ds_read_b64_tr_b16 v[90:91], v22 offset:56120
  v_mfma_f32_16x16x32_bf16 v[160:163], v[56:59], v[40:43], v[160:163]
  ds_read_b64_tr_b16 v[92:93], v22 offset:55360
  ds_read_b64_tr_b16 v[94:95], v22 offset:56128
  v_mfma_f32_16x16x32_bf16 v[168:171], v[56:59], v[44:47], v[168:171]
  ds_read_b64_tr_b16 v[96:97], v22 offset:55408
  ds_read_b64_tr_b16 v[98:99], v22 offset:56176
  v_mfma_f32_16x16x32_bf16 v[164:167], v[60:63], v[40:43], v[164:167]
  ds_read_b64_tr_b16 v[100:101], v22 offset:55416
  ds_read_b64_tr_b16 v[102:103], v22 offset:56184
  v_mfma_f32_16x16x32_bf16 v[172:175], v[60:63], v[44:47], v[172:175]
  v_mfma_f32_16x16x32_bf16 v[176:179], v[64:67], v[40:43], v[176:179]
  v_mfma_f32_16x16x32_bf16 v[184:187], v[64:67], v[44:47], v[184:187]
  v_mfma_f32_16x16x32_bf16 v[180:183], v[68:71], v[40:43], v[180:183]
  v_mfma_f32_16x16x32_bf16 v[188:191], v[68:71], v[44:47], v[188:191]
  s_waitcnt lgkmcnt(0)
  v_and_b32 v4, 1, v2
  v_mul_u32_u24 v4, 12, v4
  v_xor_b32 v4, v4, v1
  v_lshlrev_b32 v25, 4, v4
  v_cmp_eq_u32 s[74:75], 3, v2
  s_and_b32 s70, s65, 1
  s_lshl_b32 s70, s70, 3
  s_lshr_b32 s71, s66, 2
  s_add_u32 s70, s70, s71
  s_mul_i32 s81, s70, 3
  s_lshl_b32 s70, s81, 7
  s_lshr_b32 s71, s65, 1
  s_lshl_b32 s71, s71, 2
  s_and_b32 s72, s66, 3
  s_add_u32 s71, s71, s72
  s_lshl_b32 s71, s71, 3
  s_add_u32 s70, s70, s71
  s_lshl_b32 s71, s64, 1
  s_add_u32 s70, s70, s71
  s_lshl_b32 s70, s70, 10
  s_add_u32 s78, s70, 4194304
  s_add_u32 s79, s78, 0x20000
  s_add_u32 s80, s78, 0x40000
  s_add_u32 s70, s81, 0
  s_lshr_b32 s70, s70, 4
  s_cmp_eq_u32 s70, 1
  s_cselect_b32 s70, 0, 0x3f80
  v_mov_b32 v32, s70
  s_add_u32 s70, s81, 1
  s_lshr_b32 s70, s70, 4
  s_cmp_eq_u32 s70, 1
  s_cselect_b32 s70, 0, 0x3f80
  v_mov_b32 v33, s70
  s_add_u32 s70, s81, 2
  s_lshr_b32 s70, s70, 4
  s_cmp_eq_u32 s70, 1
  s_cselect_b32 s70, 0, 0x3f80
  v_mov_b32 v34, s70
  v_mov_b32 v35, 0
  s_barrier
  v_mfma_f32_16x16x32_bf16 v[144:147], v[80:83], v[72:75], v[144:147]
  ds_read_b128 v[40:43], v11 offset:0
  ds_read_b128 v[44:47], v11 offset:2048
  v_mfma_f32_16x16x32_bf16 v[152:155], v[80:83], v[76:79], v[152:155]
  ds_read_b64_tr_b16 v[48:49], v23 offset:16384
  ds_read_b64_tr_b16 v[50:51], v23 offset:17152
  v_mfma_f32_16x16x32_bf16 v[148:151], v[84:87], v[72:75], v[148:151]
  ds_read_b64_tr_b16 v[52:53], v23 offset:16392
  ds_read_b64_tr_b16 v[54:55], v23 offset:17160
  v_mfma_f32_16x16x32_bf16 v[156:159], v[84:87], v[76:79], v[156:159]
  ds_read_b64_tr_b16 v[56:57], v23 offset:16440
  ds_read_b64_tr_b16 v[58:59], v23 offset:17208
  v_mfma_f32_16x16x32_bf16 v[160:163], v[88:91], v[72:75], v[160:163]
  ds_read_b64_tr_b16 v[60:61], v23 offset:16448
  ds_read_b64_tr_b16 v[62:63], v23 offset:17216
  v_mfma_f32_16x16x32_bf16 v[168:171], v[88:91], v[76:79], v[168:171]
  ds_read_b64_tr_b16 v[64:65], v23 offset:16496
  ds_read_b64_tr_b16 v[66:67], v23 offset:17264
  v_mfma_f32_16x16x32_bf16 v[164:167], v[92:95], v[72:75], v[164:167]
  ds_read_b64_tr_b16 v[68:69], v23 offset:16504
  ds_read_b64_tr_b16 v[70:71], v23 offset:17272
  v_mfma_f32_16x16x32_bf16 v[172:175], v[92:95], v[76:79], v[172:175]
  v_mfma_f32_16x16x32_bf16 v[176:179], v[96:99], v[72:75], v[176:179]
  v_mfma_f32_16x16x32_bf16 v[184:187], v[96:99], v[76:79], v[184:187]
  v_mfma_f32_16x16x32_bf16 v[180:183], v[100:103], v[72:75], v[180:183]
  v_mfma_f32_16x16x32_bf16 v[188:191], v[100:103], v[76:79], v[188:191]
  s_waitcnt lgkmcnt(0)
  v_mfma_f32_16x16x32_bf16 v[144:147], v[48:51], v[40:43], v[144:147]
  ds_read_b128 v[72:75], v14 offset:0
  ds_read_b128 v[76:79], v14 offset:2048
  v_mfma_f32_16x16x32_bf16 v[152:155], v[48:51], v[44:47], v[152:155]
  ds_read_b64_tr_b16 v[80:81], v23 offset:22528
  ds_read_b64_tr_b16 v[82:83], v23 offset:23296
  v_mfma_f32_16x16x32_bf16 v[148:151], v[52:55], v[40:43], v[148:151]
  ds_read_b64_tr_b16 v[84:85], v23 offset:22536
  ds_read_b64_tr_b16 v[86:87], v23 offset:23304
  v_mfma_f32_16x16x32_bf16 v[156:159], v[52:55], v[44:47], v[156:159]
  ds_read_b64_tr_b16 v[88:89], v23 offset:22584
  ds_read_b64_tr_b16 v[90:91], v23 offset:23352
  v_mfma_f32_16x16x32_bf16 v[160:163], v[56:59], v[40:43], v[160:163]
  ds_read_b64_tr_b16 v[92:93], v23 offset:22592
  ds_read_b64_tr_b16 v[94:95], v23 offset:23360
  v_mfma_f32_16x16x32_bf16 v[168:171], v[56:59], v[44:47], v[168:171]
  ds_read_b64_tr_b16 v[96:97], v23 offset:22640
  ds_read_b64_tr_b16 v[98:99], v23 offset:23408
  v_mfma_f32_16x16x32_bf16 v[164:167], v[60:63], v[40:43], v[164:167]
  ds_read_b64_tr_b16 v[100:101], v23 offset:22648
  ds_read_b64_tr_b16 v[102:103], v23 offset:23416
  v_mfma_f32_16x16x32_bf16 v[172:175], v[60:63], v[44:47], v[172:175]
  v_mfma_f32_16x16x32_bf16 v[176:179], v[64:67], v[40:43], v[176:179]
  v_mfma_f32_16x16x32_bf16 v[184:187], v[64:67], v[44:47], v[184:187]
  v_mfma_f32_16x16x32_bf16 v[180:183], v[68:71], v[40:43], v[180:183]
  v_mfma_f32_16x16x32_bf16 v[188:191], v[68:71], v[44:47], v[188:191]
  s_waitcnt lgkmcnt(0)
  s_barrier
  v_mfma_f32_16x16x32_bf16 v[144:147], v[80:83], v[72:75], v[144:147]
  ds_read_b128 v[40:43], v11 offset:32768
  ds_read_b128 v[44:47], v11 offset:34816
  v_mfma_f32_16x16x32_bf16 v[152:155], v[80:83], v[76:79], v[152:155]
  ds_read_b64_tr_b16 v[48:49], v23 offset:49152
  ds_read_b64_tr_b16 v[50:51], v23 offset:49920
  v_mfma_f32_16x16x32_bf16 v[148:151], v[84:87], v[72:75], v[148:151]
  ds_read_b64_tr_b16 v[52:53], v23 offset:49160
  ds_read_b64_tr_b16 v[54:55], v23 offset:49928
  v_mfma_f32_16x16x32_bf16 v[156:159], v[84:87], v[76:79], v[156:159]
  ds_read_b64_tr_b16 v[56:57], v23 offset:49208
  ds_read_b64_tr_b16 v[58:59], v23 offset:49976
  v_mfma_f32_16x16x32_bf16 v[160:163], v[88:91], v[72:75], v[160:163]
  ds_read_b64_tr_b16 v[60:61], v23 offset:49216
  ds_read_b64_tr_b16 v[62:63], v23 offset:49984
  v_mfma_f32_16x16x32_bf16 v[168:171], v[88:91], v[76:79], v[168:171]
  ds_read_b64_tr_b16 v[64:65], v23 offset:49264
  ds_read_b64_tr_b16 v[66:67], v23 offset:50032
  v_mfma_f32_16x16x32_bf16 v[164:167], v[92:95], v[72:75], v[164:167]
  ds_read_b64_tr_b16 v[68:69], v23 offset:49272
  ds_read_b64_tr_b16 v[70:71], v23 offset:50040
  v_mfma_f32_16x16x32_bf16 v[172:175], v[92:95], v[76:79], v[172:175]
  v_mfma_f32_16x16x32_bf16 v[176:179], v[96:99], v[72:75], v[176:179]
  v_mfma_f32_16x16x32_bf16 v[184:187], v[96:99], v[76:79], v[184:187]
  v_mfma_f32_16x16x32_bf16 v[180:183], v[100:103], v[72:75], v[180:183]
  v_mfma_f32_16x16x32_bf16 v[188:191], v[100:103], v[76:79], v[188:191]
  s_waitcnt lgkmcnt(0)
  v_mfma_f32_16x16x32_bf16 v[144:147], v[48:51], v[40:43], v[144:147]
  ds_read_b128 v[72:75], v14 offset:32768
  ds_read_b128 v[76:79], v14 offset:34816
  v_mfma_f32_16x16x32_bf16 v[152:155], v[48:51], v[44:47], v[152:155]
  ds_read_b64_tr_b16 v[80:81], v23 offset:55296
  ds_read_b64_tr_b16 v[82:83], v23 offset:56064
  v_mfma_f32_16x16x32_bf16 v[148:151], v[52:55], v[40:43], v[148:151]
  ds_read_b64_tr_b16 v[84:85], v23 offset:55304
  ds_read_b64_tr_b16 v[86:87], v23 offset:56072
  v_mfma_f32_16x16x32_bf16 v[156:159], v[52:55], v[44:47], v[156:159]
  ds_read_b64_tr_b16 v[88:89], v23 offset:55352
  ds_read_b64_tr_b16 v[90:91], v23 offset:56120
  v_mfma_f32_16x16x32_bf16 v[160:163], v[56:59], v[40:43], v[160:163]
  ds_read_b64_tr_b16 v[92:93], v23 offset:55360
  ds_read_b64_tr_b16 v[94:95], v23 offset:56128
  v_mfma_f32_16x16x32_bf16 v[168:171], v[56:59], v[44:47], v[168:171]
  ds_read_b64_tr_b16 v[96:97], v23 offset:55408
  ds_read_b64_tr_b16 v[98:99], v23 offset:56176
  v_mfma_f32_16x16x32_bf16 v[164:167], v[60:63], v[40:43], v[164:167]
  ds_read_b64_tr_b16 v[100:101], v23 offset:55416
  ds_read_b64_tr_b16 v[102:103], v23 offset:56184
  v_mfma_f32_16x16x32_bf16 v[172:175], v[60:63], v[44:47], v[172:175]
  v_mfma_f32_16x16x32_bf16 v[176:179], v[64:67], v[40:43], v[176:179]
  v_mfma_f32_16x16x32_bf16 v[184:187], v[64:67], v[44:47], v[184:187]
  v_mfma_f32_16x16x32_bf16 v[180:183], v[68:71], v[40:43], v[180:183]
  v_mfma_f32_16x16x32_bf16 v[188:191], v[68:71], v[44:47], v[188:191]
  s_waitcnt lgkmcnt(0)
  s_barrier
  v_mfma_f32_16x16x32_bf16 v[144:147], v[80:83], v[72:75], v[144:147]
  v_mfma_f32_16x16x32_bf16 v[152:155], v[80:83], v[76:79], v[152:155]
  v_mfma_f32_16x16x32_bf16 v[148:151], v[84:87], v[72:75], v[148:151]
  v_mfma_f32_16x16x32_bf16 v[156:159], v[84:87], v[76:79], v[156:159]
  v_mfma_f32_16x16x32_bf16 v[160:163], v[88:91], v[72:75], v[160:163]
  v_mfma_f32_16x16x32_bf16 v[168:171], v[88:91], v[76:79], v[168:171]
  v_mfma_f32_16x16x32_bf16 v[164:167], v[92:95], v[72:75], v[164:167]
  v_mfma_f32_16x16x32_bf16 v[172:175], v[92:95], v[76:79], v[172:175]
  v_mfma_f32_16x16x32_bf16 v[176:179], v[96:99], v[72:75], v[176:179]
  v_mfma_f32_16x16x32_bf16 v[184:187], v[96:99], v[76:79], v[184:187]
  v_mfma_f32_16x16x32_bf16 v[180:183], v[100:103], v[72:75], v[180:183]
  v_mfma_f32_16x16x32_bf16 v[188:191], v[100:103], v[76:79], v[188:191]
  v_cvt_pk_bf16_f32 v144, v144, v145
  v_cvt_pk_bf16_f32 v145, v146, v147
  v_cvt_pk_bf16_f32 v146, v148, v149
  v_cvt_pk_bf16_f32 v147, v150, v151
  v_cndmask_b32 v146, v146, v32, s[74:75]
  v_cndmask_b32 v147, v147, v35, s[74:75]
  buffer_store_dwordx4 v[144:147], v25, s[52:55], s78 offen offset:0 sc1
  v_cvt_pk_bf16_f32 v152, v152, v153
  v_cvt_pk_bf16_f32 v153, v154, v155
  v_cvt_pk_bf16_f32 v154, v156, v157
  v_cvt_pk_bf16_f32 v155, v158, v159
  v_cndmask_b32 v154, v154, v32, s[74:75]
  v_cndmask_b32 v155, v155, v35, s[74:75]
  buffer_store_dwordx4 v[152:155], v25, s[52:55], s78 offen offset:1024 sc1
  v_cvt_pk_bf16_f32 v160, v160, v161
  v_cvt_pk_bf16_f32 v161, v162, v163
  v_cvt_pk_bf16_f32 v162, v164, v165
  v_cvt_pk_bf16_f32 v163, v166, v167
  v_cndmask_b32 v162, v162, v33, s[74:75]
  v_cndmask_b32 v163, v163, v35, s[74:75]
  buffer_store_dwordx4 v[160:163], v25, s[52:55], s79 offen offset:0 sc1
  v_cvt_pk_bf16_f32 v168, v168, v169
  v_cvt_pk_bf16_f32 v169, v170, v171
  v_cvt_pk_bf16_f32 v170, v172, v173
  v_cvt_pk_bf16_f32 v171, v174, v175
  v_cndmask_b32 v170, v170, v33, s[74:75]
  v_cndmask_b32 v171, v171, v35, s[74:75]
  buffer_store_dwordx4 v[168:171], v25, s[52:55], s79 offen offset:1024 sc1
  v_cvt_pk_bf16_f32 v176, v176, v177
  v_cvt_pk_bf16_f32 v177, v178, v179
  v_cvt_pk_bf16_f32 v178, v180, v181
  v_cvt_pk_bf16_f32 v179, v182, v183
  v_cndmask_b32 v178, v178, v34, s[74:75]
  v_cndmask_b32 v179, v179, v35, s[74:75]
  buffer_store_dwordx4 v[176:179], v25, s[52:55], s80 offen offset:0 sc1
  v_cvt_pk_bf16_f32 v184, v184, v185
  v_cvt_pk_bf16_f32 v185, v186, v187
  v_cvt_pk_bf16_f32 v186, v188, v189
  v_cvt_pk_bf16_f32 v187, v190, v191
  v_cndmask_b32 v186, v186, v34, s[74:75]
  v_cndmask_b32 v187, v187, v35, s[74:75]
  buffer_store_dwordx4 v[184:187], v25, s[52:55], s80 offen offset:1024 sc1
  v_mov_b32 v16, v5
  v_add_u32 v17, 0x10000, v16
  v_add_u32 v18, 0x20000, v16
  s_barrier
  ds_read_b128 v[40:43], v10 offset:0
  ds_read_b128 v[44:47], v10 offset:2048
  ds_read_b128 v[48:51], v18 offset:0
  ds_read_b128 v[52:55], v18 offset:1024
  ds_read_b128 v[56:59], v18 offset:2048
  ds_read_b128 v[60:63], v18 offset:3072
  ds_read_b128 v[64:67], v18 offset:4096
  ds_read_b128 v[68:71], v18 offset:5120
  ds_read_b128 v[72:75], v18 offset:6144
  s_waitcnt lgkmcnt(0)
  v_mfma_f32_16x16x32_bf16 v[200:203], v[48:51], v[40:43], 0
  ds_read_b128 v[76:79], v13 offset:0
  v_mfma_f32_16x16x32_bf16 v[228:231], v[48:51], v[44:47], 0
  ds_read_b128 v[80:83], v13 offset:2048
  v_mfma_f32_16x16x32_bf16 v[204:207], v[52:55], v[40:43], 0
  ds_read_b128 v[84:87], v18 offset:7168
  v_mfma_f32_16x16x32_bf16 v[232:235], v[52:55], v[44:47], 0
  ds_read_b128 v[88:91], v18 offset:8192
  v_mfma_f32_16x16x32_bf16 v[208:211], v[56:59], v[40:43], 0
  ds_read_b128 v[92:95], v18 offset:9216
  v_mfma_f32_16x16x32_bf16 v[236:239], v[56:59], v[44:47], 0
  ds_read_b128 v[96:99], v18 offset:10240
  v_mfma_f32_16x16x32_bf16 v[212:215], v[60:63], v[40:43], 0
  ds_read_b128 v[100:103], v18 offset:11264
  v_mfma_f32_16x16x32_bf16 v[240:243], v[60:63], v[44:47], 0
  ds_read_b128 v[104:107], v18 offset:12288
  v_mfma_f32_16x16x32_bf16 v[216:219], v[64:67], v[40:43], 0
  ds_read_b128 v[108:111], v18 offset:13312
  v_mfma_f32_16x16x32_bf16 v[244:247], v[64:67], v[44:47], 0
  v_mfma_f32_16x16x32_bf16 v[220:223], v[68:71], v[40:43], 0
  v_mfma_f32_16x16x32_bf16 v[248:251], v[68:71], v[44:47], 0
  v_mfma_f32_16x16x32_bf16 v[224:227], v[72:75], v[40:43], 0
  v_mfma_f32_16x16x32_bf16 v[252:255], v[72:75], v[44:47], 0
  s_waitcnt lgkmcnt(0)
  s_waitcnt vmcnt(0)
  s_add_u32 s70, s26, 32768
  v_mov_b32 v36, s68
  s_mov_b64 exec, 1
  buffer_store_dword v36, v37, s[52:55], s70 offen sc1
  s_mov_b64 exec, -1
  s_barrier
  v_mfma_f32_16x16x32_bf16 v[200:203], v[84:87], v[76:79], v[200:203]
  ds_read_b128 v[40:43], v10 offset:16384
  v_mfma_f32_16x16x32_bf16 v[228:231], v[84:87], v[80:83], v[228:231]
  ds_read_b128 v[44:47], v10 offset:18432
  v_mfma_f32_16x16x32_bf16 v[204:207], v[88:91], v[76:79], v[204:207]
  ds_read_b128 v[48:51], v18 offset:16384
  v_mfma_f32_16x16x32_bf16 v[232:235], v[88:91], v[80:83], v[232:235]
  ds_read_b128 v[52:55], v18 offset:17408
  v_mfma_f32_16x16x32_bf16 v[208:211], v[92:95], v[76:79], v[208:211]
  ds_read_b128 v[56:59], v18 offset:18432
  v_mfma_f32_16x16x32_bf16 v[236:239], v[92:95], v[80:83], v[236:239]
  ds_read_b128 v[60:63], v18 offset:19456
  v_mfma_f32_16x16x32_bf16 v[212:215], v[96:99], v[76:79], v[212:215]
  ds_read_b128 v[64:67], v18 offset:20480
  v_mfma_f32_16x16x32_bf16 v[240:243], v[96:99], v[80:83], v[240:243]
  ds_read_b128 v[68:71], v18 offset:21504
  v_mfma_f32_16x16x32_bf16 v[216:219], v[100:103], v[76:79], v[216:219]
  ds_read_b128 v[72:75], v18 offset:22528
  v_mfma_f32_16x16x32_bf16 v[244:247], v[100:103], v[80:83], v[244:247]
  v_mfma_f32_16x16x32_bf16 v[220:223], v[104:107], v[76:79], v[220:223]
  v_mfma_f32_16x16x32_bf16 v[248:251], v[104:107], v[80:83], v[248:251]
  v_mfma_f32_16x16x32_bf16 v[224:227], v[108:111], v[76:79], v[224:227]
  v_mfma_f32_16x16x32_bf16 v[252:255], v[108:111], v[80:83], v[252:255]
  s_waitcnt lgkmcnt(0)
  v_mfma_f32_16x16x32_bf16 v[200:203], v[48:51], v[40:43], v[200:203]
  ds_read_b128 v[76:79], v13 offset:16384
  v_mfma_f32_16x16x32_bf16 v[228:231], v[48:51], v[44:47], v[228:231]
  ds_read_b128 v[80:83], v13 offset:18432
  v_mfma_f32_16x16x32_bf16 v[204:207], v[52:55], v[40:43], v[204:207]
  ds_read_b128 v[84:87], v18 offset:23552
  v_mfma_f32_16x16x32_bf16 v[232:235], v[52:55], v[44:47], v[232:235]
  ds_read_b128 v[88:91], v18 offset:24576
  v_mfma_f32_16x16x32_bf16 v[208:211], v[56:59], v[40:43], v[208:211]
  ds_read_b128 v[92:95], v18 offset:25600
  v_mfma_f32_16x16x32_bf16 v[236:239], v[56:59], v[44:47], v[236:239]
  ds_read_b128 v[96:99], v18 offset:26624
  v_mfma_f32_16x16x32_bf16 v[212:215], v[60:63], v[40:43], v[212:215]
  ds_read_b128 v[100:103], v18 offset:27648
  v_mfma_f32_16x16x32_bf16 v[240:243], v[60:63], v[44:47], v[240:243]
  ds_read_b128 v[104:107], v18 offset:28672
  v_mfma_f32_16x16x32_bf16 v[216:219], v[64:67], v[40:43], v[216:219]
  ds_read_b128 v[108:111], v18 offset:29696
  v_mfma_f32_16x16x32_bf16 v[244:247], v[64:67], v[44:47], v[244:247]
  v_mfma_f32_16x16x32_bf16 v[220:223], v[68:71], v[40:43], v[220:223]
  v_mfma_f32_16x16x32_bf16 v[248:251], v[68:71], v[44:47], v[248:251]
  v_mfma_f32_16x16x32_bf16 v[224:227], v[72:75], v[40:43], v[224:227]
  v_mfma_f32_16x16x32_bf16 v[252:255], v[72:75], v[44:47], v[252:255]
  s_waitcnt lgkmcnt(0)
  v_and_b32 v4, 1, v2
  v_mul_u32_u24 v4, 12, v4
  v_xor_b32 v4, v4, v1
  v_lshlrev_b32 v8, 4, v4
  s_lshl_b32 s70, s64, 11
  s_add_u32 s71, s70, 65536
  v_add_u32 v8, s71, v8
  v_lshrrev_b32 v4, 2, v3
  v_lshl_add_u32 v4, v2, 2, v4
  v_bfe_u32 v7, v3, 1, 1
  v_mul_u32_u24 v7, 28, v7
  v_xor_b32 v4, v4, v7
  v_lshlrev_b32 v4, 4, v4
  v_and_b32 v7, 1, v3
  v_lshl_add_u32 v4, v7, 3, v4
  s_add_u32 s71, s70, 98304
  v_add_u32 v9, s71, v4
  s_barrier
  v_mfma_f32_16x16x32_bf16 v[200:203], v[84:87], v[76:79], v[200:203]
  ds_read_b128 v[40:43], v10 offset:32768
  v_mfma_f32_16x16x32_bf16 v[228:231], v[84:87], v[80:83], v[228:231]
  ds_read_b128 v[44:47], v10 offset:34816
  v_mfma_f32_16x16x32_bf16 v[204:207], v[88:91], v[76:79], v[204:207]
  ds_read_b128 v[48:51], v16 offset:49152
  v_mfma_f32_16x16x32_bf16 v[232:235], v[88:91], v[80:83], v[232:235]
  ds_read_b128 v[52:55], v16 offset:50176
  v_mfma_f32_16x16x32_bf16 v[208:211], v[92:95], v[76:79], v[208:211]
  ds_read_b128 v[56:59], v16 offset:51200
  v_mfma_f32_16x16x32_bf16 v[236:239], v[92:95], v[80:83], v[236:239]
  ds_read_b128 v[60:63], v16 offset:52224
  v_mfma_f32_16x16x32_bf16 v[212:215], v[96:99], v[76:79], v[212:215]
  ds_read_b128 v[64:67], v16 offset:53248
  v_mfma_f32_16x16x32_bf16 v[240:243], v[96:99], v[80:83], v[240:243]
  ds_read_b128 v[68:71], v16 offset:54272
  v_mfma_f32_16x16x32_bf16 v[216:219], v[100:103], v[76:79], v[216:219]
  ds_read_b128 v[72:75], v16 offset:55296
  v_mfma_f32_16x16x32_bf16 v[244:247], v[100:103], v[80:83], v[244:247]
  v_mfma_f32_16x16x32_bf16 v[220:223], v[104:107], v[76:79], v[220:223]
  v_mfma_f32_16x16x32_bf16 v[248:251], v[104:107], v[80:83], v[248:251]
  v_mfma_f32_16x16x32_bf16 v[224:227], v[108:111], v[76:79], v[224:227]
  v_mfma_f32_16x16x32_bf16 v[252:255], v[108:111], v[80:83], v[252:255]
  s_waitcnt lgkmcnt(0)
  v_mfma_f32_16x16x32_bf16 v[200:203], v[48:51], v[40:43], v[200:203]
  ds_read_b128 v[76:79], v13 offset:32768
  v_mfma_f32_16x16x32_bf16 v[228:231], v[48:51], v[44:47], v[228:231]
  ds_read_b128 v[80:83], v13 offset:34816
  v_mfma_f32_16x16x32_bf16 v[204:207], v[52:55], v[40:43], v[204:207]
  ds_read_b128 v[84:87], v16 offset:56320
  v_mfma_f32_16x16x32_bf16 v[232:235], v[52:55], v[44:47], v[232:235]
  ds_read_b128 v[88:91], v16 offset:57344
  v_mfma_f32_16x16x32_bf16 v[208:211], v[56:59], v[40:43], v[208:211]
  ds_read_b128 v[92:95], v16 offset:58368
  v_mfma_f32_16x16x32_bf16 v[236:239], v[56:59], v[44:47], v[236:239]
  ds_read_b128 v[96:99], v16 offset:59392
  v_mfma_f32_16x16x32_bf16 v[212:215], v[60:63], v[40:43], v[212:215]
  ds_read_b128 v[100:103], v16 offset:60416
  v_mfma_f32_16x16x32_bf16 v[240:243], v[60:63], v[44:47], v[240:243]
  ds_read_b128 v[104:107], v16 offset:61440
  v_mfma_f32_16x16x32_bf16 v[216:219], v[64:67], v[40:43], v[216:219]
  ds_read_b128 v[108:111], v16 offset:62464
  v_mfma_f32_16x16x32_bf16 v[244:247], v[64:67], v[44:47], v[244:247]
  v_mfma_f32_16x16x32_bf16 v[220:223], v[68:71], v[40:43], v[220:223]
  v_mfma_f32_16x16x32_bf16 v[248:251], v[68:71], v[44:47], v[248:251]
  v_mfma_f32_16x16x32_bf16 v[224:227], v[72:75], v[40:43], v[224:227]
  v_mfma_f32_16x16x32_bf16 v[252:255], v[72:75], v[44:47], v[252:255]
  s_waitcnt lgkmcnt(0)
  v_lshlrev_b32 v4, 2, v2
  v_sub_u32 v4, v3, v4
  v_mov_b32 v7, 0xf149f2ca
  v_mov_b32 v6, 0
  v_cmp_gt_i32 s[8:9], 0, v4
  v_cmp_gt_i32 s[10:11], 1, v4
  v_cmp_gt_i32 s[12:13], 2, v4
  v_cmp_gt_i32 s[14:15], 3, v4
  v_cndmask_b32 v168, v7, v6, s[8:9]
  v_cndmask_b32 v172, v6, v7, s[8:9]
  v_cndmask_b32 v169, v7, v6, s[10:11]
  v_cndmask_b32 v173, v6, v7, s[10:11]
  v_cndmask_b32 v170, v7, v6, s[12:13]
  v_cndmask_b32 v174, v6, v7, s[12:13]
  v_cndmask_b32 v171, v7, v6, s[14:15]
  v_cndmask_b32 v175, v6, v7, s[14:15]
  s_mov_b32 s4, 0x3e8b97f6
  s_mov_b32 s5, 0x3e8b97f6
  s_lshr_b32 s71, s66, 1
  s_lshl_b32 s71, s71, 2
  s_add_u32 s71, s71, s67
  s_lshl_b32 s71, s71, 5
  s_lshl_b32 s72, s65, 1
  s_and_b32 s73, s66, 1
  s_add_u32 s72, s72, s73
  s_add_u32 s71, s71, s72
  s_lshl_b32 s71, s71, 10
  s_add_u32 s6, s71, 10485760
  s_add_u32 s7, s6, 16384
  s_barrier
  v_mfma_f32_16x16x32_bf16 v[200:203], v[84:87], v[76:79], v[200:203]
  ds_read_b128 v[40:43], v11 offset:0
  v_mfma_f32_16x16x32_bf16 v[228:231], v[84:87], v[80:83], v[228:231]
  ds_read_b128 v[44:47], v11 offset:2048
  v_mfma_f32_16x16x32_bf16 v[204:207], v[88:91], v[76:79], v[204:207]
  ds_read_b128 v[48:51], v17 offset:16384
  v_mfma_f32_16x16x32_bf16 v[232:235], v[88:91], v[80:83], v[232:235]
  ds_read_b128 v[52:55], v17 offset:17408
  v_mfma_f32_16x16x32_bf16 v[208:211], v[92:95], v[76:79], v[208:211]
  ds_read_b128 v[56:59], v17 offset:18432
  v_mfma_f32_16x16x32_bf16 v[236:239], v[92:95], v[80:83], v[236:239]
  ds_read_b128 v[60:63], v17 offset:19456
  v_mfma_f32_16x16x32_bf16 v[212:215], v[96:99], v[76:79], v[212:215]
  ds_read_b128 v[64:67], v17 offset:20480
  v_mfma_f32_16x16x32_bf16 v[240:243], v[96:99], v[80:83], v[240:243]
  ds_read_b128 v[68:71], v17 offset:21504
  v_mfma_f32_16x16x32_bf16 v[216:219], v[100:103], v[76:79], v[216:219]
  ds_read_b128 v[72:75], v17 offset:22528
  v_mfma_f32_16x16x32_bf16 v[244:247], v[100:103], v[80:83], v[244:247]
  v_mfma_f32_16x16x32_bf16 v[220:223], v[104:107], v[76:79], v[220:223]
  v_mfma_f32_16x16x32_bf16 v[248:251], v[104:107], v[80:83], v[248:251]
  v_mfma_f32_16x16x32_bf16 v[224:227], v[108:111], v[76:79], v[224:227]
  v_mfma_f32_16x16x32_bf16 v[252:255], v[108:111], v[80:83], v[252:255]
  s_waitcnt lgkmcnt(0)
  v_mfma_f32_16x16x32_bf16 v[200:203], v[48:51], v[40:43], v[200:203]
  ds_read_b128 v[76:79], v14 offset:0
  v_mfma_f32_16x16x32_bf16 v[228:231], v[48:51], v[44:47], v[228:231]
  ds_read_b128 v[80:83], v14 offset:2048
  v_mfma_f32_16x16x32_bf16 v[204:207], v[52:55], v[40:43], v[204:207]
  ds_read_b128 v[84:87], v17 offset:23552
  v_mfma_f32_16x16x32_bf16 v[232:235], v[52:55], v[44:47], v[232:235]
  ds_read_b128 v[88:91], v17 offset:24576
  v_mfma_f32_16x16x32_bf16 v[208:211], v[56:59], v[40:43], v[208:211]
  ds_read_b128 v[92:95], v17 offset:25600
  v_mfma_f32_16x16x32_bf16 v[236:239], v[56:59], v[44:47], v[236:239]
  ds_read_b128 v[96:99], v17 offset:26624
  v_mfma_f32_16x16x32_bf16 v[212:215], v[60:63], v[40:43], v[212:215]
  ds_read_b128 v[100:103], v17 offset:27648
  v_mfma_f32_16x16x32_bf16 v[240:243], v[60:63], v[44:47], v[240:243]
  ds_read_b128 v[104:107], v17 offset:28672
  v_mfma_f32_16x16x32_bf16 v[216:219], v[64:67], v[40:43], v[216:219]
  ds_read_b128 v[108:111], v17 offset:29696
  v_mfma_f32_16x16x32_bf16 v[244:247], v[64:67], v[44:47], v[244:247]
  v_mfma_f32_16x16x32_bf16 v[220:223], v[68:71], v[40:43], v[220:223]
  v_mfma_f32_16x16x32_bf16 v[248:251], v[68:71], v[44:47], v[248:251]
  v_mfma_f32_16x16x32_bf16 v[224:227], v[72:75], v[40:43], v[224:227]
  v_mfma_f32_16x16x32_bf16 v[252:255], v[72:75], v[44:47], v[252:255]
  s_waitcnt lgkmcnt(0)
  s_cmp_eq_u32 s64, 3
  s_cbranch_scc0 L_ow_25
  s_lshr_b32 s71, s66, 1
  s_lshl_b32 s70, s65, 1
  s_and_b32 s72, s66, 1
  s_add_u32 s70, s70, s72
  v_min_u32 v4, 2, v2
  v_lshl_add_u32 v4, v4, 4, s70
  v_mul_u32_u24 v4, 0x5556, v4
  v_lshrrev_b32 v4, 16, v4
  v_lshrrev_b32 v39, 2, v3
  v_min_u32 v39, 2, v39
  v_cmp_eq_u32 vcc, 0, v2
  s_nop 1
  v_cndmask_b32 v39, v39, v37, vcc
  v_sub_u32 v39, s71, v39
  v_max_i32 v39, 0, v39
  v_and_b32 v36, 7, v4
  v_lshrrev_b32 v4, 3, v4
  v_lshl_add_u32 v4, v36, 5, v4
  v_and_b32 v36, 3, v39
  v_lshl_add_u32 v4, v36, 3, v4
  v_lshrrev_b32 v39, 2, v39
  v_lshl_add_u32 v4, v39, 1, v4
  v_and_b32 v39, 3, v1
  v_lshl_add_u32 v39, v4, 3, v39
  v_and_b32 v4, 7, v39
  v_lshrrev_b32 v39, 3, v39
  v_lshlrev_b32 v39, 7, v39
  v_lshl_add_u32 v39, v4, 2, v39
  v_add_u32 v39, 21004288, v39
  buffer_load_dword v38, v39, s[52:55], 0 offen sc1
L_ow_25:
  s_barrier
  v_mfma_f32_16x16x32_bf16 v[200:203], v[84:87], v[76:79], v[200:203]
  ds_read_b128 v[40:43], v11 offset:32768
  v_mfma_f32_16x16x32_bf16 v[228:231], v[84:87], v[80:83], v[228:231]
  ds_read_b128 v[44:47], v11 offset:34816
  v_mfma_f32_16x16x32_bf16 v[204:207], v[88:91], v[76:79], v[204:207]
  ds_read_b128 v[48:51], v17 offset:49152
  v_mfma_f32_16x16x32_bf16 v[232:235], v[88:91], v[80:83], v[232:235]
  ds_read_b128 v[52:55], v17 offset:50176
  v_mfma_f32_16x16x32_bf16 v[208:211], v[92:95], v[76:79], v[208:211]
  ds_read_b128 v[56:59], v17 offset:51200
  v_mfma_f32_16x16x32_bf16 v[236:239], v[92:95], v[80:83], v[236:239]
  ds_read_b128 v[60:63], v17 offset:52224
  v_mfma_f32_16x16x32_bf16 v[212:215], v[96:99], v[76:79], v[212:215]
  ds_read_b128 v[64:67], v17 offset:53248
  v_mfma_f32_16x16x32_bf16 v[240:243], v[96:99], v[80:83], v[240:243]
  ds_read_b128 v[68:71], v17 offset:54272
  v_mfma_f32_16x16x32_bf16 v[216:219], v[100:103], v[76:79], v[216:219]
  ds_read_b128 v[72:75], v17 offset:55296
  v_mfma_f32_16x16x32_bf16 v[244:247], v[100:103], v[80:83], v[244:247]
  v_mfma_f32_16x16x32_bf16 v[220:223], v[104:107], v[76:79], v[220:223]
  v_mfma_f32_16x16x32_bf16 v[248:251], v[104:107], v[80:83], v[248:251]
  v_mfma_f32_16x16x32_bf16 v[224:227], v[108:111], v[76:79], v[224:227]
  v_mfma_f32_16x16x32_bf16 v[252:255], v[108:111], v[80:83], v[252:255]
  s_waitcnt lgkmcnt(0)
  v_mfma_f32_16x16x32_bf16 v[200:203], v[48:51], v[40:43], v[200:203]
  ds_read_b128 v[76:79], v14 offset:32768
  v_mfma_f32_16x16x32_bf16 v[228:231], v[48:51], v[44:47], v[228:231]
  ds_read_b128 v[80:83], v14 offset:34816
  v_mfma_f32_16x16x32_bf16 v[204:207], v[52:55], v[40:43], v[204:207]
  ds_read_b128 v[84:87], v17 offset:56320
  v_mfma_f32_16x16x32_bf16 v[232:235], v[52:55], v[44:47], v[232:235]
  ds_read_b128 v[88:91], v17 offset:57344
  v_mfma_f32_16x16x32_bf16 v[208:211], v[56:59], v[40:43], v[208:211]
  ds_read_b128 v[92:95], v17 offset:58368
  v_mfma_f32_16x16x32_bf16 v[236:239], v[56:59], v[44:47], v[236:239]
  ds_read_b128 v[96:99], v17 offset:59392
  v_mfma_f32_16x16x32_bf16 v[212:215], v[60:63], v[40:43], v[212:215]
  ds_read_b128 v[100:103], v17 offset:60416
  v_mfma_f32_16x16x32_bf16 v[240:243], v[60:63], v[44:47], v[240:243]
  ds_read_b128 v[104:107], v17 offset:61440
  v_mfma_f32_16x16x32_bf16 v[216:219], v[64:67], v[40:43], v[216:219]
  ds_read_b128 v[108:111], v17 offset:62464
  v_mfma_f32_16x16x32_bf16 v[244:247], v[64:67], v[44:47], v[244:247]
  v_mfma_f32_16x16x32_bf16 v[220:223], v[68:71], v[40:43], v[220:223]
  v_mfma_f32_16x16x32_bf16 v[248:251], v[68:71], v[44:47], v[248:251]
  v_mfma_f32_16x16x32_bf16 v[224:227], v[72:75], v[40:43], v[224:227]
  v_mfma_f32_16x16x32_bf16 v[252:255], v[72:75], v[44:47], v[252:255]
  s_waitcnt lgkmcnt(0)
  s_barrier
  v_mfma_f32_16x16x32_bf16 v[200:203], v[84:87], v[76:79], v[200:203]
  ds_read_b128 v[40:43], v10 offset:0
  v_mfma_f32_16x16x32_bf16 v[228:231], v[84:87], v[80:83], v[228:231]
  ds_read_b128 v[44:47], v10 offset:2048
  v_mfma_f32_16x16x32_bf16 v[204:207], v[88:91], v[76:79], v[204:207]
  ds_read_b128 v[48:51], v18 offset:0
  v_mfma_f32_16x16x32_bf16 v[232:235], v[88:91], v[80:83], v[232:235]
  ds_read_b128 v[52:55], v18 offset:1024
  v_mfma_f32_16x16x32_bf16 v[208:211], v[92:95], v[76:79], v[208:211]
  ds_read_b128 v[56:59], v18 offset:2048
  v_mfma_f32_16x16x32_bf16 v[236:239], v[92:95], v[80:83], v[236:239]
  ds_read_b128 v[60:63], v18 offset:3072
  v_mfma_f32_16x16x32_bf16 v[212:215], v[96:99], v[76:79], v[212:215]
  ds_read_b128 v[64:67], v18 offset:4096
  v_mfma_f32_16x16x32_bf16 v[240:243], v[96:99], v[80:83], v[240:243]
  ds_read_b128 v[68:71], v18 offset:5120
  v_mfma_f32_16x16x32_bf16 v[216:219], v[100:103], v[76:79], v[216:219]
  ds_read_b128 v[72:75], v18 offset:6144
  v_mfma_f32_16x16x32_bf16 v[244:247], v[100:103], v[80:83], v[244:247]
  v_mfma_f32_16x16x32_bf16 v[220:223], v[104:107], v[76:79], v[220:223]
  v_mfma_f32_16x16x32_bf16 v[248:251], v[104:107], v[80:83], v[248:251]
  v_mfma_f32_16x16x32_bf16 v[224:227], v[108:111], v[76:79], v[224:227]
  v_mfma_f32_16x16x32_bf16 v[252:255], v[108:111], v[80:83], v[252:255]
  s_waitcnt lgkmcnt(0)
  v_mfma_f32_16x16x32_bf16 v[200:203], v[48:51], v[40:43], v[200:203]
  ds_read_b128 v[76:79], v13 offset:0
  v_mfma_f32_16x16x32_bf16 v[228:231], v[48:51], v[44:47], v[228:231]
  ds_read_b128 v[80:83], v13 offset:2048
  v_mfma_f32_16x16x32_bf16 v[204:207], v[52:55], v[40:43], v[204:207]
  ds_read_b128 v[84:87], v18 offset:7168
  v_mfma_f32_16x16x32_bf16 v[232:235], v[52:55], v[44:47], v[232:235]
  ds_read_b128 v[88:91], v18 offset:8192
  v_mfma_f32_16x16x32_bf16 v[208:211], v[56:59], v[40:43], v[208:211]
  ds_read_b128 v[92:95], v18 offset:9216
  v_mfma_f32_16x16x32_bf16 v[236:239], v[56:59], v[44:47], v[236:239]
  ds_read_b128 v[96:99], v18 offset:10240
  v_mfma_f32_16x16x32_bf16 v[212:215], v[60:63], v[40:43], v[212:215]
  ds_read_b128 v[100:103], v18 offset:11264
  v_mfma_f32_16x16x32_bf16 v[240:243], v[60:63], v[44:47], v[240:243]
  ds_read_b128 v[104:107], v18 offset:12288
  v_mfma_f32_16x16x32_bf16 v[216:219], v[64:67], v[40:43], v[216:219]
  ds_read_b128 v[108:111], v18 offset:13312
  v_mfma_f32_16x16x32_bf16 v[244:247], v[64:67], v[44:47], v[244:247]
  v_mfma_f32_16x16x32_bf16 v[220:223], v[68:71], v[40:43], v[220:223]
  v_mfma_f32_16x16x32_bf16 v[248:251], v[68:71], v[44:47], v[248:251]
  v_mfma_f32_16x16x32_bf16 v[224:227], v[72:75], v[40:43], v[224:227]
  v_mfma_f32_16x16x32_bf16 v[252:255], v[72:75], v[44:47], v[252:255]
  s_waitcnt lgkmcnt(0)
  s_cmp_eq_u32 s64, 3
  s_cbranch_scc0 L_ow_26
  s_mov_b32 s69, 0
L_sp_27:
  s_waitcnt vmcnt(0)
  v_cmp_ne_u32 vcc, s68, v38
  s_nop 1
  s_cbranch_vccz L_ok_28
  s_mov_b64 exec, vcc
  s_add_u32 s69, s69, 1
  s_cmp_ge_u32 s69, 0x40000
  s_cbranch_scc1 L_ok_28
  s_sleep 1
  buffer_load_dword v38, v39, s[52:55], 0 offen sc1
  s_branch L_sp_27
L_ok_28:
  s_mov_b64 exec, -1
L_ow_26:
  s_barrier
  v_mfma_f32_16x16x32_bf16 v[200:203], v[84:87], v[76:79], v[200:203]
  ds_read_b128 v[40:43], v10 offset:16384
  v_mfma_f32_16x16x32_bf16 v[228:231], v[84:87], v[80:83], v[228:231]
  ds_read_b128 v[44:47], v10 offset:18432
  v_mfma_f32_16x16x32_bf16 v[204:207], v[88:91], v[76:79], v[204:207]
  ds_read_b128 v[48:51], v18 offset:16384
  v_mfma_f32_16x16x32_bf16 v[232:235], v[88:91], v[80:83], v[232:235]
  ds_read_b128 v[52:55], v18 offset:17408
  v_mfma_f32_16x16x32_bf16 v[208:211], v[92:95], v[76:79], v[208:211]
  ds_read_b128 v[56:59], v18 offset:18432
  v_mfma_f32_16x16x32_bf16 v[236:239], v[92:95], v[80:83], v[236:239]
  ds_read_b128 v[60:63], v18 offset:19456
  v_mfma_f32_16x16x32_bf16 v[212:215], v[96:99], v[76:79], v[212:215]
  ds_read_b128 v[64:67], v18 offset:20480
  v_mfma_f32_16x16x32_bf16 v[240:243], v[96:99], v[80:83], v[240:243]
  ds_read_b128 v[68:71], v18 offset:21504
  v_mfma_f32_16x16x32_bf16 v[216:219], v[100:103], v[76:79], v[216:219]
  ds_read_b128 v[72:75], v18 offset:22528
  v_mfma_f32_16x16x32_bf16 v[244:247], v[100:103], v[80:83], v[244:247]
  v_mfma_f32_16x16x32_bf16 v[220:223], v[104:107], v[76:79], v[220:223]
  v_mfma_f32_16x16x32_bf16 v[248:251], v[104:107], v[80:83], v[248:251]
  v_mfma_f32_16x16x32_bf16 v[224:227], v[108:111], v[76:79], v[224:227]
  v_mfma_f32_16x16x32_bf16 v[252:255], v[108:111], v[80:83], v[252:255]
  s_waitcnt lgkmcnt(0)
  v_mfma_f32_16x16x32_bf16 v[200:203], v[48:51], v[40:43], v[200:203]
  ds_read_b128 v[76:79], v13 offset:16384
  v_mfma_f32_16x16x32_bf16 v[228:231], v[48:51], v[44:47], v[228:231]
  ds_read_b128 v[80:83], v13 offset:18432
  v_mfma_f32_16x16x32_bf16 v[204:207], v[52:55], v[40:43], v[204:207]
  ds_read_b128 v[84:87], v18 offset:23552
  v_mfma_f32_16x16x32_bf16 v[232:235], v[52:55], v[44:47], v[232:235]
  ds_read_b128 v[88:91], v18 offset:24576
  v_mfma_f32_16x16x32_bf16 v[208:211], v[56:59], v[40:43], v[208:211]
  ds_read_b128 v[92:95], v18 offset:25600
  v_mfma_f32_16x16x32_bf16 v[236:239], v[56:59], v[44:47], v[236:239]
  ds_read_b128 v[96:99], v18 offset:26624
  v_mfma_f32_16x16x32_bf16 v[212:215], v[60:63], v[40:43], v[212:215]
  ds_read_b128 v[100:103], v18 offset:27648
  v_mfma_f32_16x16x32_bf16 v[240:243], v[60:63], v[44:47], v[240:243]
  ds_read_b128 v[104:107], v18 offset:28672
  v_mfma_f32_16x16x32_bf16 v[216:219], v[64:67], v[40:43], v[216:219]
  ds_read_b128 v[108:111], v18 offset:29696
  v_mfma_f32_16x16x32_bf16 v[244:247], v[64:67], v[44:47], v[244:247]
  v_mfma_f32_16x16x32_bf16 v[220:223], v[68:71], v[40:43], v[220:223]
  v_mfma_f32_16x16x32_bf16 v[248:251], v[68:71], v[44:47], v[248:251]
  v_mfma_f32_16x16x32_bf16 v[224:227], v[72:75], v[40:43], v[224:227]
  v_mfma_f32_16x16x32_bf16 v[252:255], v[72:75], v[44:47], v[252:255]
  s_waitcnt lgkmcnt(0)
  s_barrier
  v_mfma_f32_16x16x32_bf16 v[200:203], v[84:87], v[76:79], v[200:203]
  ds_read_b128 v[40:43], v10 offset:32768
  v_mfma_f32_16x16x32_bf16 v[228:231], v[84:87], v[80:83], v[228:231]
  ds_read_b128 v[44:47], v10 offset:34816
  v_mfma_f32_16x16x32_bf16 v[204:207], v[88:91], v[76:79], v[204:207]
  ds_read_b128 v[48:51], v16 offset:49152
  v_mfma_f32_16x16x32_bf16 v[232:235], v[88:91], v[80:83], v[232:235]
  ds_read_b128 v[52:55], v16 offset:50176
  v_mfma_f32_16x16x32_bf16 v[208:211], v[92:95], v[76:79], v[208:211]
  ds_read_b128 v[56:59], v16 offset:51200
  v_mfma_f32_16x16x32_bf16 v[236:239], v[92:95], v[80:83], v[236:239]
  ds_read_b128 v[60:63], v16 offset:52224
  v_mfma_f32_16x16x32_bf16 v[212:215], v[96:99], v[76:79], v[212:215]
  ds_read_b128 v[64:67], v16 offset:53248
  v_mfma_f32_16x16x32_bf16 v[240:243], v[96:99], v[80:83], v[240:243]
  ds_read_b128 v[68:71], v16 offset:54272
  v_mfma_f32_16x16x32_bf16 v[216:219], v[100:103], v[76:79], v[216:219]
  ds_read_b128 v[72:75], v16 offset:55296
  v_mfma_f32_16x16x32_bf16 v[244:247], v[100:103], v[80:83], v[244:247]
  v_mfma_f32_16x16x32_bf16 v[220:223], v[104:107], v[76:79], v[220:223]
  v_mfma_f32_16x16x32_bf16 v[248:251], v[104:107], v[80:83], v[248:251]
  v_mfma_f32_16x16x32_bf16 v[224:227], v[108:111], v[76:79], v[224:227]
  v_mfma_f32_16x16x32_bf16 v[252:255], v[108:111], v[80:83], v[252:255]
  s_waitcnt lgkmcnt(0)
  v_mfma_f32_16x16x32_bf16 v[200:203], v[48:51], v[40:43], v[200:203]
  ds_read_b128 v[76:79], v13 offset:32768
  v_mfma_f32_16x16x32_bf16 v[228:231], v[48:51], v[44:47], v[228:231]
  ds_read_b128 v[80:83], v13 offset:34816
  v_mfma_f32_16x16x32_bf16 v[204:207], v[52:55], v[40:43], v[204:207]
  ds_read_b128 v[84:87], v16 offset:56320
  v_mfma_f32_16x16x32_bf16 v[232:235], v[52:55], v[44:47], v[232:235]
  ds_read_b128 v[88:91], v16 offset:57344
  v_mfma_f32_16x16x32_bf16 v[208:211], v[56:59], v[40:43], v[208:211]
  ds_read_b128 v[92:95], v16 offset:58368
  v_mfma_f32_16x16x32_bf16 v[236:239], v[56:59], v[44:47], v[236:239]
  ds_read_b128 v[96:99], v16 offset:59392
  v_mfma_f32_16x16x32_bf16 v[212:215], v[60:63], v[40:43], v[212:215]
  ds_read_b128 v[100:103], v16 offset:60416
  v_mfma_f32_16x16x32_bf16 v[240:243], v[60:63], v[44:47], v[240:243]
  ds_read_b128 v[104:107], v16 offset:61440
  v_mfma_f32_16x16x32_bf16 v[216:219], v[64:67], v[40:43], v[216:219]
  ds_read_b128 v[108:111], v16 offset:62464
  v_mfma_f32_16x16x32_bf16 v[244:247], v[64:67], v[44:47], v[244:247]
  v_mfma_f32_16x16x32_bf16 v[220:223], v[68:71], v[40:43], v[220:223]
  v_mfma_f32_16x16x32_bf16 v[248:251], v[68:71], v[44:47], v[248:251]
  v_mfma_f32_16x16x32_bf16 v[224:227], v[72:75], v[40:43], v[224:227]
  v_mfma_f32_16x16x32_bf16 v[252:255], v[72:75], v[44:47], v[252:255]
  s_waitcnt lgkmcnt(0)
  s_barrier
  v_mfma_f32_16x16x32_bf16 v[200:203], v[84:87], v[76:79], v[200:203]
  ds_read_b128 v[12:15], v8 offset:24576
  v_mfma_f32_16x16x32_bf16 v[228:231], v[84:87], v[80:83], v[228:231]
  ds_read_b128 v[16:19], v8 offset:25600
  v_mfma_f32_16x16x32_bf16 v[204:207], v[88:91], v[76:79], v[204:207]
  ds_read_b128 v[176:179], v8 offset:0
  v_mfma_f32_16x16x32_bf16 v[232:235], v[88:91], v[80:83], v[232:235]
  ds_read_b128 v[180:183], v8 offset:1024
  v_mfma_f32_16x16x32_bf16 v[208:211], v[92:95], v[76:79], v[208:211]
  ds_read_b128 v[184:187], v8 offset:2048
  v_mfma_f32_16x16x32_bf16 v[236:239], v[92:95], v[80:83], v[236:239]
  ds_read_b128 v[188:191], v8 offset:3072
  v_mfma_f32_16x16x32_bf16 v[212:215], v[96:99], v[76:79], v[212:215]
  ds_read_b128 v[20:23], v8 offset:4096
  v_mfma_f32_16x16x32_bf16 v[240:243], v[96:99], v[80:83], v[240:243]
  ds_read_b128 v[24:27], v8 offset:5120
  v_mfma_f32_16x16x32_bf16 v[216:219], v[100:103], v[76:79], v[216:219]
  ds_read_b128 v[28:31], v8 offset:6144
  v_mfma_f32_16x16x32_bf16 v[244:247], v[100:103], v[80:83], v[244:247]
  v_mfma_f32_16x16x32_bf16 v[220:223], v[104:107], v[76:79], v[220:223]
  v_mfma_f32_16x16x32_bf16 v[248:251], v[104:107], v[80:83], v[248:251]
  v_mfma_f32_16x16x32_bf16 v[224:227], v[108:111], v[76:79], v[224:227]
  v_mfma_f32_16x16x32_bf16 v[252:255], v[108:111], v[80:83], v[252:255]
  s_waitcnt lgkmcnt(6)
  v_mfma_f32_16x16x32_bf16 v[40:43], v[176:179], v[12:15], v[168:171]
  ds_read_b128 v[32:35], v8 offset:7168
  s_waitcnt lgkmcnt(6)
  v_mfma_f32_16x16x32_bf16 v[44:47], v[180:183], v[12:15], 0
  ds_read_b128 v[176:179], v8 offset:8192
  v_mfma_f32_16x16x32_bf16 v[108:111], v[180:183], v[16:19], v[168:171]
  s_waitcnt lgkmcnt(6)
  v_mfma_f32_16x16x32_bf16 v[48:51], v[184:187], v[12:15], 0
  ds_read_b128 v[180:183], v8 offset:9216
  v_mfma_f32_16x16x32_bf16 v[112:115], v[184:187], v[16:19], 0
  v_max_f32 v192, v40, v41
  v_max_f32 v193, v42, v43
  s_waitcnt lgkmcnt(6)
  v_mfma_f32_16x16x32_bf16 v[52:55], v[188:191], v[12:15], 0
  ds_read_b128 v[184:187], v8 offset:10240
  v_max3_f32 v192, v192, v45, v46
  v_max3_f32 v193, v193, v44, v47
  v_mfma_f32_16x16x32_bf16 v[116:119], v[188:191], v[16:19], 0
  v_max_f32 v194, v108, v109
  v_max_f32 v195, v110, v111
  s_waitcnt lgkmcnt(6)
  v_mfma_f32_16x16x32_bf16 v[56:59], v[20:23], v[12:15], 0
  ds_read_b128 v[188:191], v8 offset:11264
  v_max3_f32 v192, v192, v49, v50
  v_max3_f32 v193, v193, v48, v51
  v_mfma_f32_16x16x32_bf16 v[120:123], v[20:23], v[16:19], 0
  v_max3_f32 v194, v194, v112, v115
  v_max3_f32 v195, v195, v113, v114
  s_waitcnt lgkmcnt(6)
  v_mfma_f32_16x16x32_bf16 v[60:63], v[24:27], v[12:15], 0
  ds_read_b128 v[20:23], v8 offset:12288
  v_max3_f32 v192, v192, v53, v54
  v_max3_f32 v193, v193, v52, v55
  v_mfma_f32_16x16x32_bf16 v[124:127], v[24:27], v[16:19], 0
  v_max3_f32 v194, v194, v116, v119
  v_max3_f32 v195, v195, v117, v118
  s_waitcnt lgkmcnt(6)
  v_mfma_f32_16x16x32_bf16 v[64:67], v[28:31], v[12:15], 0
  ds_read_b128 v[24:27], v8 offset:13312
  v_max3_f32 v192, v192, v57, v58
  v_max3_f32 v193, v193, v56, v59
  v_mfma_f32_16x16x32_bf16 v[128:131], v[28:31], v[16:19], 0
  v_max3_f32 v194, v194, v120, v123
  v_max3_f32 v195, v195, v121, v122
  s_waitcnt lgkmcnt(6)
  v_mfma_f32_16x16x32_bf16 v[68:71], v[32:35], v[12:15], 0
  ds_read_b128 v[28:31], v8 offset:14336
  v_max3_f32 v192, v192, v61, v62
  v_max3_f32 v193, v193, v60, v63
  v_mfma_f32_16x16x32_bf16 v[132:135], v[32:35], v[16:19], 0
  v_max3_f32 v194, v194, v124, v127
  v_max3_f32 v195, v195, v125, v126
  s_waitcnt lgkmcnt(6)
  v_mfma_f32_16x16x32_bf16 v[72:75], v[176:179], v[12:15], 0
  ds_read_b128 v[32:35], v8 offset:15360
  v_max3_f32 v192, v192, v65, v66
  v_max3_f32 v193, v193, v64, v67
  v_mfma_f32_16x16x32_bf16 v[136:139], v[176:179], v[16:19], 0
  v_max3_f32 v194, v194, v128, v131
  v_max3_f32 v195, v195, v129, v130
  s_waitcnt lgkmcnt(6)
  v_mfma_f32_16x16x32_bf16 v[76:79], v[180:183], v[12:15], 0
  ds_read_b128 v[176:179], v8 offset:16384
  v_max3_f32 v192, v192, v69, v70
  v_max3_f32 v193, v193, v68, v71
  v_mfma_f32_16x16x32_bf16 v[140:143], v[180:183], v[16:19], 0
  v_max3_f32 v194, v194, v132, v135
  v_max3_f32 v195, v195, v133, v134
  s_waitcnt lgkmcnt(6)
  v_mfma_f32_16x16x32_bf16 v[80:83], v[184:187], v[12:15], 0
  ds_read_b128 v[180:183], v8 offset:17408
  v_max3_f32 v192, v192, v73, v74
  v_max3_f32 v193, v193, v72, v75
  v_mfma_f32_16x16x32_bf16 v[144:147], v[184:187], v[16:19], 0
  v_max3_f32 v194, v194, v136, v139
  v_max3_f32 v195, v195, v137, v138
  s_waitcnt lgkmcnt(6)
  v_mfma_f32_16x16x32_bf16 v[84:87], v[188:191], v[12:15], 0
  v_max3_f32 v192, v192, v77, v78
  v_max3_f32 v193, v193, v76, v79
  v_mfma_f32_16x16x32_bf16 v[148:151], v[188:191], v[16:19], 0
  v_max3_f32 v194, v194, v140, v143
  v_max3_f32 v195, v195, v141, v142
  s_waitcnt lgkmcnt(5)
  v_mfma_f32_16x16x32_bf16 v[88:91], v[20:23], v[12:15], 0
  v_max3_f32 v192, v192, v81, v82
  v_max3_f32 v193, v193, v80, v83
  v_mfma_f32_16x16x32_bf16 v[152:155], v[20:23], v[16:19], 0
  v_max3_f32 v194, v194, v144, v147
  v_max3_f32 v195, v195, v145, v146
  s_waitcnt lgkmcnt(4)
  v_mfma_f32_16x16x32_bf16 v[92:95], v[24:27], v[12:15], 0
  v_max3_f32 v192, v192, v85, v86
  v_max3_f32 v193, v193, v84, v87
  v_mfma_f32_16x16x32_bf16 v[156:159], v[24:27], v[16:19], 0
  v_max3_f32 v194, v194, v148, v151
  v_max3_f32 v195, v195, v149, v150
  s_waitcnt lgkmcnt(3)
  v_mfma_f32_16x16x32_bf16 v[96:99], v[28:31], v[12:15], 0
  v_max3_f32 v192, v192, v89, v90
  v_max3_f32 v193, v193, v88, v91
  v_mfma_f32_16x16x32_bf16 v[160:163], v[28:31], v[16:19], 0
  v_max3_f32 v194, v194, v152, v155
  v_max3_f32 v195, v195, v153, v154
  s_waitcnt lgkmcnt(2)
  v_mfma_f32_16x16x32_bf16 v[100:103], v[32:35], v[12:15], 0
  v_max3_f32 v192, v192, v93, v94
  v_max3_f32 v193, v193, v92, v95
  v_mfma_f32_16x16x32_bf16 v[164:167], v[32:35], v[16:19], 0
  v_max3_f32 v194, v194, v156, v159
  v_max3_f32 v195, v195, v157, v158
  s_waitcnt lgkmcnt(1)
  v_mfma_f32_16x16x32_bf16 v[104:107], v[176:179], v[12:15], v[172:175]
  v_max3_f32 v192, v192, v97, v98
  v_max3_f32 v193, v193, v96, v99
  v_mfma_f32_16x16x32_bf16 v[168:171], v[176:179], v[16:19], 0
  v_max3_f32 v194, v194, v160, v163
  v_max3_f32 v195, v195, v161, v162
  s_waitcnt lgkmcnt(0)
  v_mfma_f32_16x16x32_bf16 v[172:175], v[180:183], v[16:19], v[172:175]
  v_max3_f32 v192, v192, v101, v102
  v_max3_f32 v193, v193, v100, v103
  s_barrier
  ds_read_b64_tr_b16 v[176:177], v9 offset:0
  ds_read_b64_tr_b16 v[178:179], v9 offset:1024
  ds_read_b64_tr_b16 v[180:181], v9 offset:512
  ds_read_b64_tr_b16 v[182:183], v9 offset:1536
  v_and_b32 v4, 7, v3
  v_xor_b32 v4, v4, v2
  v_lshlrev_b32 v4, 4, v4
  v_lshl_add_u32 v10, v3, 7, v4
  v_xor_b32 v13, 64, v10
  s_lshl_b32 s70, s64, 12
  v_add_u32 v10, s70, v10
  v_add_u32 v13, s70, v13
  v_add_u32 v11, 0x10000, v10
  v_add_u32 v12, 0x20000, v10
  v_add_u32 v14, 0x10000, v13
  v_add_u32 v15, 0x20000, v13
  v_mov_b32 v16, v5
  v_add_u32 v17, 0x10000, v16
  v_add_u32 v18, 0x20000, v16
  v_max3_f32 v194, v194, v164, v167
  v_max3_f32 v195, v195, v165, v166
  v_max3_f32 v192, v192, v105, v106
  v_max3_f32 v193, v193, v104, v107
  v_max3_f32 v194, v194, v168, v171
  v_max3_f32 v195, v195, v169, v170
  v_max3_f32 v194, v194, v172, v175
  v_max3_f32 v195, v195, v173, v174
  v_max_f32 v192, v192, v193
  v_max_f32 v194, v194, v195
  v_mov_b32 v193, v192
  v_mov_b32 v195, v194
  s_nop 0
  v_permlane16_swap_b32 v192, v193
  v_permlane16_swap_b32 v194, v195
  v_max_f32 v192, v192, v193
  v_max_f32 v194, v194, v195
  v_mov_b32 v193, v192
  v_mov_b32 v195, v194
  s_nop 0
  v_permlane32_swap_b32 v192, v193
  v_permlane32_swap_b32 v194, v195
  v_max_f32 v192, v192, v193
  v_max_f32 v194, v194, v195
  v_mul_f32 v192, s4, v192
  v_mul_f32 v194, s4, v194
  v_sub_f32 v192, 0, v192
  v_sub_f32 v194, 0, v194
  v_mov_b32 v193, v192
  v_mov_b32 v195, v194
  v_pk_fma_f32 v[40:41], v[40:41], s[4:5], v[192:193]
  v_pk_fma_f32 v[42:43], v[42:43], s[4:5], v[192:193]
  v_pk_fma_f32 v[44:45], v[44:45], s[4:5], v[192:193]
  v_pk_fma_f32 v[46:47], v[46:47], s[4:5], v[192:193]
  v_exp_f32 v40, v40
  v_exp_f32 v41, v41
  v_exp_f32 v42, v42
  v_exp_f32 v43, v43
  v_exp_f32 v44, v44
  v_pk_fma_f32 v[108:109], v[108:109], s[4:5], v[194:195]
  v_exp_f32 v45, v45
  v_pk_fma_f32 v[110:111], v[110:111], s[4:5], v[194:195]
  v_exp_f32 v46, v46
  v_exp_f32 v47, v47
  v_exp_f32 v108, v108
  v_exp_f32 v109, v109
  v_exp_f32 v110, v110
  v_cvt_pk_bf16_f32 v40, v40, v41
  v_cvt_pk_bf16_f32 v41, v42, v43
  v_cvt_pk_bf16_f32 v42, v44, v45
  v_cvt_pk_bf16_f32 v43, v46, v47
  v_exp_f32 v111, v111
  v_pk_fma_f32 v[48:49], v[48:49], s[4:5], v[192:193]
  v_pk_fma_f32 v[50:51], v[50:51], s[4:5], v[192:193]
  v_pk_fma_f32 v[52:53], v[52:53], s[4:5], v[192:193]
  v_pk_fma_f32 v[54:55], v[54:55], s[4:5], v[192:193]
  v_exp_f32 v48, v48
  s_waitcnt lgkmcnt(0)
  v_mfma_f32_16x16x32_bf16 v[20:23], v[176:179], v[40:43], 0
  ds_read_b64_tr_b16 v[184:185], v9 offset:2048
  ds_read_b64_tr_b16 v[186:187], v9 offset:3072
  v_exp_f32 v49, v49
  v_mfma_f32_16x16x32_bf16 v[24:27], v[180:183], v[40:43], 0
  ds_read_b64_tr_b16 v[188:189], v9 offset:2560
  ds_read_b64_tr_b16 v[190:191], v9 offset:3584
  v_exp_f32 v50, v50
  v_cvt_pk_bf16_f32 v111, v110, v111
  v_cvt_pk_bf16_f32 v110, v108, v109
  v_exp_f32 v51, v51
  v_mov_b32 v108, 0
  v_mov_b32 v109, 0
  v_exp_f32 v52, v52
  v_pk_fma_f32 v[112:113], v[112:113], s[4:5], v[194:195]
  v_exp_f32 v53, v53
  v_pk_fma_f32 v[114:115], v[114:115], s[4:5], v[194:195]
  v_exp_f32 v54, v54
  v_pk_fma_f32 v[116:117], v[116:117], s[4:5], v[194:195]
  v_exp_f32 v55, v55
  v_pk_fma_f32 v[118:119], v[118:119], s[4:5], v[194:195]
  v_exp_f32 v112, v112
  v_mfma_f32_16x16x32_bf16 v[28:31], v[176:179], v[108:111], 0
  v_exp_f32 v113, v113
  v_mfma_f32_16x16x32_bf16 v[32:35], v[180:183], v[108:111], 0
  v_exp_f32 v114, v114
  v_cvt_pk_bf16_f32 v48, v48, v49
  v_cvt_pk_bf16_f32 v49, v50, v51
  v_exp_f32 v115, v115
  v_cvt_pk_bf16_f32 v50, v52, v53
  v_cvt_pk_bf16_f32 v51, v54, v55
  v_exp_f32 v116, v116
  v_pk_fma_f32 v[56:57], v[56:57], s[4:5], v[192:193]
  v_exp_f32 v117, v117
  v_pk_fma_f32 v[58:59], v[58:59], s[4:5], v[192:193]
  v_exp_f32 v118, v118
  v_pk_fma_f32 v[60:61], v[60:61], s[4:5], v[192:193]
  v_exp_f32 v119, v119
  v_pk_fma_f32 v[62:63], v[62:63], s[4:5], v[192:193]
  v_exp_f32 v56, v56
  s_waitcnt lgkmcnt(0)
  v_mfma_f32_16x16x32_bf16 v[20:23], v[184:187], v[48:51], v[20:23]
  ds_read_b64_tr_b16 v[176:177], v9 offset:4096
  ds_read_b64_tr_b16 v[178:179], v9 offset:5120
  v_exp_f32 v57, v57
  v_mfma_f32_16x16x32_bf16 v[24:27], v[188:191], v[48:51], v[24:27]
  ds_read_b64_tr_b16 v[180:181], v9 offset:4608
  ds_read_b64_tr_b16 v[182:183], v9 offset:5632
  v_exp_f32 v58, v58
  v_cvt_pk_bf16_f32 v112, v112, v113
  v_cvt_pk_bf16_f32 v113, v114, v115
  v_exp_f32 v59, v59
  v_cvt_pk_bf16_f32 v114, v116, v117
  v_cvt_pk_bf16_f32 v115, v118, v119
  v_exp_f32 v60, v60
  v_pk_fma_f32 v[120:121], v[120:121], s[4:5], v[194:195]
  v_exp_f32 v61, v61
  v_pk_fma_f32 v[122:123], v[122:123], s[4:5], v[194:195]
  v_exp_f32 v62, v62
  v_pk_fma_f32 v[124:125], v[124:125], s[4:5], v[194:195]
  v_exp_f32 v63, v63
  v_pk_fma_f32 v[126:127], v[126:127], s[4:5], v[194:195]
  v_exp_f32 v120, v120
  v_mfma_f32_16x16x32_bf16 v[28:31], v[184:187], v[112:115], v[28:31]
  v_exp_f32 v121, v121
  v_mfma_f32_16x16x32_bf16 v[32:35], v[188:191], v[112:115], v[32:35]
  v_exp_f32 v122, v122
  v_cvt_pk_bf16_f32 v56, v56, v57
  v_cvt_pk_bf16_f32 v57, v58, v59
  v_exp_f32 v123, v123
  v_cvt_pk_bf16_f32 v58, v60, v61
  v_cvt_pk_bf16_f32 v59, v62, v63
  v_exp_f32 v124, v124
  v_pk_fma_f32 v[64:65], v[64:65], s[4:5], v[192:193]
  v_exp_f32 v125, v125
  v_pk_fma_f32 v[66:67], v[66:67], s[4:5], v[192:193]
  v_exp_f32 v126, v126
  v_pk_fma_f32 v[68:69], v[68:69], s[4:5], v[192:193]
  v_exp_f32 v127, v127
  v_pk_fma_f32 v[70:71], v[70:71], s[4:5], v[192:193]
  v_exp_f32 v64, v64
  s_waitcnt lgkmcnt(0)
  v_mfma_f32_16x16x32_bf16 v[20:23], v[176:179], v[56:59], v[20:23]
  ds_read_b64_tr_b16 v[184:185], v9 offset:6144
  ds_read_b64_tr_b16 v[186:187], v9 offset:7168
  v_exp_f32 v65, v65
  v_mfma_f32_16x16x32_bf16 v[24:27], v[180:183], v[56:59], v[24:27]
  ds_read_b64_tr_b16 v[188:189], v9 offset:6656
  ds_read_b64_tr_b16 v[190:191], v9 offset:7680
  v_exp_f32 v66, v66
  v_cvt_pk_bf16_f32 v120, v120, v121
  v_cvt_pk_bf16_f32 v121, v122, v123
  v_exp_f32 v67, v67
  v_cvt_pk_bf16_f32 v122, v124, v125
  v_cvt_pk_bf16_f32 v123, v126, v127
  v_exp_f32 v68, v68
  v_pk_fma_f32 v[128:129], v[128:129], s[4:5], v[194:195]
  v_exp_f32 v69, v69
  v_pk_fma_f32 v[130:131], v[130:131], s[4:5], v[194:195]
  v_exp_f32 v70, v70
  v_pk_fma_f32 v[132:133], v[132:133], s[4:5], v[194:195]
  v_exp_f32 v71, v71
  v_pk_fma_f32 v[134:135], v[134:135], s[4:5], v[194:195]
  v_exp_f32 v128, v128
  v_mfma_f32_16x16x32_bf16 v[28:31], v[176:179], v[120:123], v[28:31]
  v_exp_f32 v129, v129
  v_mfma_f32_16x16x32_bf16 v[32:35], v[180:183], v[120:123], v[32:35]
  v_exp_f32 v130, v130
  v_cvt_pk_bf16_f32 v64, v64, v65
  v_cvt_pk_bf16_f32 v65, v66, v67
  v_exp_f32 v131, v131
  v_cvt_pk_bf16_f32 v66, v68, v69
  v_cvt_pk_bf16_f32 v67, v70, v71
  v_exp_f32 v132, v132
  v_pk_fma_f32 v[72:73], v[72:73], s[4:5], v[192:193]
  v_exp_f32 v133, v133
  v_pk_fma_f32 v[74:75], v[74:75], s[4:5], v[192:193]
  v_exp_f32 v134, v134
  v_pk_fma_f32 v[76:77], v[76:77], s[4:5], v[192:193]
  v_exp_f32 v135, v135
  v_pk_fma_f32 v[78:79], v[78:79], s[4:5], v[192:193]
  v_exp_f32 v72, v72
  s_waitcnt lgkmcnt(0)
  v_mfma_f32_16x16x32_bf16 v[20:23], v[184:187], v[64:67], v[20:23]
  ds_read_b64_tr_b16 v[176:177], v9 offset:8192
  ds_read_b64_tr_b16 v[178:179], v9 offset:9216
  v_exp_f32 v73, v73
  v_mfma_f32_16x16x32_bf16 v[24:27], v[188:191], v[64:67], v[24:27]
  ds_read_b64_tr_b16 v[180:181], v9 offset:8704
  ds_read_b64_tr_b16 v[182:183], v9 offset:9728
  v_exp_f32 v74, v74
  v_cvt_pk_bf16_f32 v128, v128, v129
  v_cvt_pk_bf16_f32 v129, v130, v131
  v_exp_f32 v75, v75
  v_cvt_pk_bf16_f32 v130, v132, v133
  v_cvt_pk_bf16_f32 v131, v134, v135
  v_exp_f32 v76, v76
  v_pk_fma_f32 v[136:137], v[136:137], s[4:5], v[194:195]
  v_exp_f32 v77, v77
  v_pk_fma_f32 v[138:139], v[138:139], s[4:5], v[194:195]
  v_exp_f32 v78, v78
  v_pk_fma_f32 v[140:141], v[140:141], s[4:5], v[194:195]
  v_exp_f32 v79, v79
  v_pk_fma_f32 v[142:143], v[142:143], s[4:5], v[194:195]
  v_exp_f32 v136, v136
  v_mfma_f32_16x16x32_bf16 v[28:31], v[184:187], v[128:131], v[28:31]
  v_exp_f32 v137, v137
  v_mfma_f32_16x16x32_bf16 v[32:35], v[188:191], v[128:131], v[32:35]
  v_exp_f32 v138, v138
  v_cvt_pk_bf16_f32 v72, v72, v73
  v_cvt_pk_bf16_f32 v73, v74, v75
  v_exp_f32 v139, v139
  v_cvt_pk_bf16_f32 v74, v76, v77
  v_cvt_pk_bf16_f32 v75, v78, v79
  v_exp_f32 v140, v140
  v_pk_fma_f32 v[80:81], v[80:81], s[4:5], v[192:193]
  v_exp_f32 v141, v141
  v_pk_fma_f32 v[82:83], v[82:83], s[4:5], v[192:193]
  v_exp_f32 v142, v142
  v_pk_fma_f32 v[84:85], v[84:85], s[4:5], v[192:193]
  v_exp_f32 v143, v143
  v_pk_fma_f32 v[86:87], v[86:87], s[4:5], v[192:193]
  v_exp_f32 v80, v80
  s_waitcnt lgkmcnt(0)
  v_mfma_f32_16x16x32_bf16 v[20:23], v[176:179], v[72:75], v[20:23]
  ds_read_b64_tr_b16 v[184:185], v9 offset:10240
  ds_read_b64_tr_b16 v[186:187], v9 offset:11264
  v_exp_f32 v81, v81
  v_mfma_f32_16x16x32_bf16 v[24:27], v[180:183], v[72:75], v[24:27]
  ds_read_b64_tr_b16 v[188:189], v9 offset:10752
  ds_read_b64_tr_b16 v[190:191], v9 offset:11776
  v_exp_f32 v82, v82
  v_cvt_pk_bf16_f32 v136, v136, v137
  v_cvt_pk_bf16_f32 v137, v138, v139
  v_exp_f32 v83, v83
  v_cvt_pk_bf16_f32 v138, v140, v141
  v_cvt_pk_bf16_f32 v139, v142, v143
  v_exp_f32 v84, v84
  v_pk_fma_f32 v[144:145], v[144:145], s[4:5], v[194:195]
  v_exp_f32 v85, v85
  v_pk_fma_f32 v[146:147], v[146:147], s[4:5], v[194:195]
  v_exp_f32 v86, v86
  v_pk_fma_f32 v[148:149], v[148:149], s[4:5], v[194:195]
  v_exp_f32 v87, v87
  v_pk_fma_f32 v[150:151], v[150:151], s[4:5], v[194:195]
  v_exp_f32 v144, v144
  v_mfma_f32_16x16x32_bf16 v[28:31], v[176:179], v[136:139], v[28:31]
  v_exp_f32 v145, v145
  v_mfma_f32_16x16x32_bf16 v[32:35], v[180:183], v[136:139], v[32:35]
  v_exp_f32 v146, v146
  v_cvt_pk_bf16_f32 v80, v80, v81
  v_cvt_pk_bf16_f32 v81, v82, v83
  v_exp_f32 v147, v147
  v_cvt_pk_bf16_f32 v82, v84, v85
  v_cvt_pk_bf16_f32 v83, v86, v87
  v_exp_f32 v148, v148
  v_pk_fma_f32 v[88:89], v[88:89], s[4:5], v[192:193]
  v_exp_f32 v149, v149
  v_pk_fma_f32 v[90:91], v[90:91], s[4:5], v[192:193]
  v_exp_f32 v150, v150
  v_pk_fma_f32 v[92:93], v[92:93], s[4:5], v[192:193]
  v_exp_f32 v151, v151
  v_pk_fma_f32 v[94:95], v[94:95], s[4:5], v[192:193]
  v_exp_f32 v88, v88
  s_waitcnt lgkmcnt(0)
  v_mfma_f32_16x16x32_bf16 v[20:23], v[184:187], v[80:83], v[20:23]
  ds_read_b64_tr_b16 v[176:177], v9 offset:12288
  ds_read_b64_tr_b16 v[178:179], v9 offset:13312
  v_exp_f32 v89, v89
  v_mfma_f32_16x16x32_bf16 v[24:27], v[188:191], v[80:83], v[24:27]
  ds_read_b64_tr_b16 v[180:181], v9 offset:12800
  ds_read_b64_tr_b16 v[182:183], v9 offset:13824
  v_exp_f32 v90, v90
  v_cvt_pk_bf16_f32 v144, v144, v145
  v_cvt_pk_bf16_f32 v145, v146, v147
  v_exp_f32 v91, v91
  v_cvt_pk_bf16_f32 v146, v148, v149
  v_cvt_pk_bf16_f32 v147, v150, v151
  v_exp_f32 v92, v92
  v_pk_fma_f32 v[152:153], v[152:153], s[4:5], v[194:195]
  v_exp_f32 v93, v93
  v_pk_fma_f32 v[154:155], v[154:155], s[4:5], v[194:195]
  v_exp_f32 v94, v94
  v_pk_fma_f32 v[156:157], v[156:157], s[4:5], v[194:195]
  v_exp_f32 v95, v95
  v_pk_fma_f32 v[158:159], v[158:159], s[4:5], v[194:195]
  v_exp_f32 v152, v152
  v_mfma_f32_16x16x32_bf16 v[28:31], v[184:187], v[144:147], v[28:31]
  v_exp_f32 v153, v153
  v_mfma_f32_16x16x32_bf16 v[32:35], v[188:191], v[144:147], v[32:35]
  v_exp_f32 v154, v154
  v_cvt_pk_bf16_f32 v88, v88, v89
  v_cvt_pk_bf16_f32 v89, v90, v91
  v_exp_f32 v155, v155
  v_cvt_pk_bf16_f32 v90, v92, v93
  v_cvt_pk_bf16_f32 v91, v94, v95
  v_exp_f32 v156, v156
  v_pk_fma_f32 v[96:97], v[96:97], s[4:5], v[192:193]
  v_exp_f32 v157, v157
  v_pk_fma_f32 v[98:99], v[98:99], s[4:5], v[192:193]
  v_exp_f32 v158, v158
  v_pk_fma_f32 v[100:101], v[100:101], s[4:5], v[192:193]
  v_exp_f32 v159, v159
  v_pk_fma_f32 v[102:103], v[102:103], s[4:5], v[192:193]
  v_exp_f32 v96, v96
  s_waitcnt lgkmcnt(0)
  v_mfma_f32_16x16x32_bf16 v[20:23], v[176:179], v[88:91], v[20:23]
  ds_read_b64_tr_b16 v[184:185], v9 offset:14336
  ds_read_b64_tr_b16 v[186:187], v9 offset:15360
  v_exp_f32 v97, v97
  v_mfma_f32_16x16x32_bf16 v[24:27], v[180:183], v[88:91], v[24:27]
  ds_read_b64_tr_b16 v[188:189], v9 offset:14848
  ds_read_b64_tr_b16 v[190:191], v9 offset:15872
  v_exp_f32 v98, v98
  v_cvt_pk_bf16_f32 v152, v152, v153
  v_cvt_pk_bf16_f32 v153, v154, v155
  v_exp_f32 v99, v99
  v_cvt_pk_bf16_f32 v154, v156, v157
  v_cvt_pk_bf16_f32 v155, v158, v159
  v_exp_f32 v100, v100
  v_pk_fma_f32 v[160:161], v[160:161], s[4:5], v[194:195]
  v_exp_f32 v101, v101
  v_pk_fma_f32 v[162:163], v[162:163], s[4:5], v[194:195]
  v_exp_f32 v102, v102
  v_pk_fma_f32 v[164:165], v[164:165], s[4:5], v[194:195]
  v_exp_f32 v103, v103
  v_pk_fma_f32 v[166:167], v[166:167], s[4:5], v[194:195]
  v_exp_f32 v160, v160
  v_mfma_f32_16x16x32_bf16 v[28:31], v[176:179], v[152:155], v[28:31]
  v_exp_f32 v161, v161
  v_mfma_f32_16x16x32_bf16 v[32:35], v[180:183], v[152:155], v[32:35]
  v_exp_f32 v162, v162
  v_cvt_pk_bf16_f32 v96, v96, v97
  v_cvt_pk_bf16_f32 v97, v98, v99
  v_exp_f32 v163, v163
  v_cvt_pk_bf16_f32 v98, v100, v101
  v_cvt_pk_bf16_f32 v99, v102, v103
  v_exp_f32 v164, v164
  v_pk_fma_f32 v[104:105], v[104:105], s[4:5], v[192:193]
  v_exp_f32 v165, v165
  v_pk_fma_f32 v[106:107], v[106:107], s[4:5], v[192:193]
  v_exp_f32 v166, v166
  v_exp_f32 v167, v167
  v_exp_f32 v104, v104
  s_waitcnt lgkmcnt(0)
  v_mfma_f32_16x16x32_bf16 v[20:23], v[184:187], v[96:99], v[20:23]
  ds_read_b64_tr_b16 v[176:177], v9 offset:16384
  ds_read_b64_tr_b16 v[178:179], v9 offset:17408
  v_exp_f32 v105, v105
  v_mfma_f32_16x16x32_bf16 v[24:27], v[188:191], v[96:99], v[24:27]
  ds_read_b64_tr_b16 v[180:181], v9 offset:16896
  ds_read_b64_tr_b16 v[182:183], v9 offset:17920
  v_exp_f32 v106, v106
  v_cvt_pk_bf16_f32 v160, v160, v161
  v_cvt_pk_bf16_f32 v161, v162, v163
  v_cvt_pk_bf16_f32 v162, v164, v165
  v_cvt_pk_bf16_f32 v163, v166, v167
  v_exp_f32 v107, v107
  v_pk_fma_f32 v[168:169], v[168:169], s[4:5], v[194:195]
  v_pk_fma_f32 v[170:171], v[170:171], s[4:5], v[194:195]
  v_pk_fma_f32 v[172:173], v[172:173], s[4:5], v[194:195]
  v_pk_fma_f32 v[174:175], v[174:175], s[4:5], v[194:195]
  v_exp_f32 v168, v168
  v_mfma_f32_16x16x32_bf16 v[28:31], v[184:187], v[160:163], v[28:31]
  v_exp_f32 v169, v169
  v_mfma_f32_16x16x32_bf16 v[32:35], v[188:191], v[160:163], v[32:35]
  v_exp_f32 v170, v170
  v_cvt_pk_bf16_f32 v104, v104, v105
  v_cvt_pk_bf16_f32 v105, v106, v107
  v_exp_f32 v171, v171
  v_mov_b32 v106, 0
  v_mov_b32 v107, 0
  v_exp_f32 v172, v172
  v_exp_f32 v173, v173
  v_exp_f32 v174, v174
  v_exp_f32 v175, v175
  s_waitcnt lgkmcnt(0)
  v_mfma_f32_16x16x32_bf16 v[20:23], v[176:179], v[104:107], v[20:23]
  v_mfma_f32_16x16x32_bf16 v[24:27], v[180:183], v[104:107], v[24:27]
  v_cvt_pk_bf16_f32 v168, v168, v169
  v_cvt_pk_bf16_f32 v169, v170, v171
  v_cvt_pk_bf16_f32 v170, v172, v173
  v_cvt_pk_bf16_f32 v171, v174, v175
  s_nop 1
  v_mfma_f32_16x16x32_bf16 v[28:31], v[176:179], v[168:171], v[28:31]
  v_mfma_f32_16x16x32_bf16 v[32:35], v[180:183], v[168:171], v[32:35]
  s_barrier
  ds_read_b128 v[40:43], v10 offset:0
  ds_read_b128 v[44:47], v10 offset:2048
  ds_read_b128 v[48:51], v18 offset:0
  ds_read_b128 v[52:55], v18 offset:1024
  ds_read_b128 v[56:59], v18 offset:2048
  ds_read_b128 v[60:63], v18 offset:3072
  ds_read_b128 v[64:67], v18 offset:4096
  ds_read_b128 v[68:71], v18 offset:5120
  ds_read_b128 v[72:75], v18 offset:6144
  v_cmp_eq_u32 vcc, 3, v2
  v_mov_b32 v6, 0
  v_mov_b32 v192, v24
  v_mov_b32 v193, v24
  v_mov_b32 v194, v32
  v_mov_b32 v195, v32
  v_permlane32_swap_b32 v192, v193
  s_nop 0
  v_permlane32_swap_b32 v194, v195
  v_mov_b32 v192, v193
  v_mov_b32 v194, v195
  s_nop 0
  v_permlane16_swap_b32 v192, v193
  v_permlane16_swap_b32 v194, v195
  v_rcp_f32 v192, v193
  v_rcp_f32 v194, v195
  v_mul_f32 v20, v20, v192
  v_mul_f32 v21, v21, v192
  v_mul_f32 v22, v22, v192
  v_mul_f32 v23, v23, v192
  v_mul_f32 v24, v24, v192
  v_mul_f32 v25, v25, v192
  v_mul_f32 v26, v26, v192
  v_mul_f32 v27, v27, v192
  v_cvt_pk_bf16_f32 v20, v20, v21
  v_cvt_pk_bf16_f32 v21, v22, v23
  v_cvt_pk_bf16_f32 v22, v24, v25
  v_cvt_pk_bf16_f32 v23, v26, v27
  v_cndmask_b32 v22, v22, v6, vcc
  v_cndmask_b32 v23, v23, v6, vcc
  buffer_store_dwordx4 v[20:23], v5, s[52:55], s6 offen sc1
  v_mul_f32 v28, v28, v194
  v_mul_f32 v29, v29, v194
  v_mul_f32 v30, v30, v194
  v_mul_f32 v31, v31, v194
  v_mul_f32 v32, v32, v194
  v_mul_f32 v33, v33, v194
  v_mul_f32 v34, v34, v194
  v_mul_f32 v35, v35, v194
  v_cvt_pk_bf16_f32 v28, v28, v29
  v_cvt_pk_bf16_f32 v29, v30, v31
  v_cvt_pk_bf16_f32 v30, v32, v33
  v_cvt_pk_bf16_f32 v31, v34, v35
  v_cndmask_b32 v30, v30, v6, vcc
  v_cndmask_b32 v31, v31, v6, vcc
  buffer_store_dwordx4 v[28:31], v5, s[52:55], s7 offen sc1
  s_waitcnt lgkmcnt(0)
  v_mfma_f32_16x16x32_bf16 v[200:203], v[48:51], v[40:43], v[200:203]
  ds_read_b128 v[76:79], v13 offset:0
  v_mfma_f32_16x16x32_bf16 v[228:231], v[48:51], v[44:47], v[228:231]
  ds_read_b128 v[80:83], v13 offset:2048
  v_mfma_f32_16x16x32_bf16 v[204:207], v[52:55], v[40:43], v[204:207]
  ds_read_b128 v[84:87], v18 offset:7168
  v_mfma_f32_16x16x32_bf16 v[232:235], v[52:55], v[44:47], v[232:235]
  ds_read_b128 v[88:91], v18 offset:8192
  v_mfma_f32_16x16x32_bf16 v[208:211], v[56:59], v[40:43], v[208:211]
  ds_read_b128 v[92:95], v18 offset:9216
  v_mfma_f32_16x16x32_bf16 v[236:239], v[56:59], v[44:47], v[236:239]
  ds_read_b128 v[96:99], v18 offset:10240
  v_mfma_f32_16x16x32_bf16 v[212:215], v[60:63], v[40:43], v[212:215]
  ds_read_b128 v[100:103], v18 offset:11264
  v_mfma_f32_16x16x32_bf16 v[240:243], v[60:63], v[44:47], v[240:243]
  ds_read_b128 v[104:107], v18 offset:12288
  v_mfma_f32_16x16x32_bf16 v[216:219], v[64:67], v[40:43], v[216:219]
  ds_read_b128 v[108:111], v18 offset:13312
  v_mfma_f32_16x16x32_bf16 v[244:247], v[64:67], v[44:47], v[244:247]
  v_mfma_f32_16x16x32_bf16 v[220:223], v[68:71], v[40:43], v[220:223]
  v_mfma_f32_16x16x32_bf16 v[248:251], v[68:71], v[44:47], v[248:251]
  v_mfma_f32_16x16x32_bf16 v[224:227], v[72:75], v[40:43], v[224:227]
  v_mfma_f32_16x16x32_bf16 v[252:255], v[72:75], v[44:47], v[252:255]
  s_waitcnt lgkmcnt(0)
  s_and_b32 s70, s65, 1
  s_lshl_b32 s70, s70, 5
  s_add_u32 s70, s70, s66
  s_lshl_b32 s70, s70, 2
  s_add_u32 s70, s70, s64
  s_lshl_b32 s70, s70, 2
  s_lshr_b32 s71, s65, 1
  s_add_u32 s70, s70, s71
  s_mul_i32 s76, s70, 7168
  s_add_u32 s76, s76, 12582912
  s_add_u32 s77, s76, 4096
  s_barrier
  v_mfma_f32_16x16x32_bf16 v[200:203], v[84:87], v[76:79], v[200:203]
  ds_read_b128 v[40:43], v10 offset:16384
  v_mfma_f32_16x16x32_bf16 v[228:231], v[84:87], v[80:83], v[228:231]
  ds_read_b128 v[44:47], v10 offset:18432
  v_mfma_f32_16x16x32_bf16 v[204:207], v[88:91], v[76:79], v[204:207]
  ds_read_b128 v[48:51], v18 offset:16384
  v_mfma_f32_16x16x32_bf16 v[232:235], v[88:91], v[80:83], v[232:235]
  ds_read_b128 v[52:55], v18 offset:17408
  v_mfma_f32_16x16x32_bf16 v[208:211], v[92:95], v[76:79], v[208:211]
  ds_read_b128 v[56:59], v18 offset:18432
  v_mfma_f32_16x16x32_bf16 v[236:239], v[92:95], v[80:83], v[236:239]
  ds_read_b128 v[60:63], v18 offset:19456
  v_mfma_f32_16x16x32_bf16 v[212:215], v[96:99], v[76:79], v[212:215]
  ds_read_b128 v[64:67], v18 offset:20480
  v_mfma_f32_16x16x32_bf16 v[240:243], v[96:99], v[80:83], v[240:243]
  ds_read_b128 v[68:71], v18 offset:21504
  v_mfma_f32_16x16x32_bf16 v[216:219], v[100:103], v[76:79], v[216:219]
  ds_read_b128 v[72:75], v18 offset:22528
  v_mfma_f32_16x16x32_bf16 v[244:247], v[100:103], v[80:83], v[244:247]
  v_mfma_f32_16x16x32_bf16 v[220:223], v[104:107], v[76:79], v[220:223]
  v_mfma_f32_16x16x32_bf16 v[248:251], v[104:107], v[80:83], v[248:251]
  v_mfma_f32_16x16x32_bf16 v[224:227], v[108:111], v[76:79], v[224:227]
  v_mfma_f32_16x16x32_bf16 v[252:255], v[108:111], v[80:83], v[252:255]
  s_waitcnt lgkmcnt(0)
  v_mfma_f32_16x16x32_bf16 v[200:203], v[48:51], v[40:43], v[200:203]
  ds_read_b128 v[76:79], v13 offset:16384
  v_mfma_f32_16x16x32_bf16 v[228:231], v[48:51], v[44:47], v[228:231]
  ds_read_b128 v[80:83], v13 offset:18432
  v_mfma_f32_16x16x32_bf16 v[204:207], v[52:55], v[40:43], v[204:207]
  ds_read_b128 v[84:87], v18 offset:23552
  v_mfma_f32_16x16x32_bf16 v[232:235], v[52:55], v[44:47], v[232:235]
  ds_read_b128 v[88:91], v18 offset:24576
  v_mfma_f32_16x16x32_bf16 v[208:211], v[56:59], v[40:43], v[208:211]
  ds_read_b128 v[92:95], v18 offset:25600
  v_mfma_f32_16x16x32_bf16 v[236:239], v[56:59], v[44:47], v[236:239]
  ds_read_b128 v[96:99], v18 offset:26624
  v_mfma_f32_16x16x32_bf16 v[212:215], v[60:63], v[40:43], v[212:215]
  ds_read_b128 v[100:103], v18 offset:27648
  v_mfma_f32_16x16x32_bf16 v[240:243], v[60:63], v[44:47], v[240:243]
  ds_read_b128 v[104:107], v18 offset:28672
  v_mfma_f32_16x16x32_bf16 v[216:219], v[64:67], v[40:43], v[216:219]
  ds_read_b128 v[108:111], v18 offset:29696
  v_mfma_f32_16x16x32_bf16 v[244:247], v[64:67], v[44:47], v[244:247]
  v_mfma_f32_16x16x32_bf16 v[220:223], v[68:71], v[40:43], v[220:223]
  v_mfma_f32_16x16x32_bf16 v[248:251], v[68:71], v[44:47], v[248:251]
  v_mfma_f32_16x16x32_bf16 v[224:227], v[72:75], v[40:43], v[224:227]
  v_mfma_f32_16x16x32_bf16 v[252:255], v[72:75], v[44:47], v[252:255]
  s_waitcnt lgkmcnt(0)
  s_waitcnt vmcnt(0)
  s_add_u32 s70, s26, 65536
  v_mov_b32 v36, s68
  s_mov_b64 exec, 1
  buffer_store_dword v36, v37, s[52:55], s70 offen sc1
  s_mov_b64 exec, -1
  s_barrier
  v_mfma_f32_16x16x32_bf16 v[200:203], v[84:87], v[76:79], v[200:203]
  ds_read_b128 v[40:43], v10 offset:32768
  v_mfma_f32_16x16x32_bf16 v[228:231], v[84:87], v[80:83], v[228:231]
  ds_read_b128 v[44:47], v10 offset:34816
  v_mfma_f32_16x16x32_bf16 v[204:207], v[88:91], v[76:79], v[204:207]
  ds_read_b128 v[48:51], v16 offset:49152
  v_mfma_f32_16x16x32_bf16 v[232:235], v[88:91], v[80:83], v[232:235]
  ds_read_b128 v[52:55], v16 offset:50176
  v_mfma_f32_16x16x32_bf16 v[208:211], v[92:95], v[76:79], v[208:211]
  ds_read_b128 v[56:59], v16 offset:51200
  v_mfma_f32_16x16x32_bf16 v[236:239], v[92:95], v[80:83], v[236:239]
  ds_read_b128 v[60:63], v16 offset:52224
  v_mfma_f32_16x16x32_bf16 v[212:215], v[96:99], v[76:79], v[212:215]
  ds_read_b128 v[64:67], v16 offset:53248
  v_mfma_f32_16x16x32_bf16 v[240:243], v[96:99], v[80:83], v[240:243]
  ds_read_b128 v[68:71], v16 offset:54272
  v_mfma_f32_16x16x32_bf16 v[216:219], v[100:103], v[76:79], v[216:219]
  ds_read_b128 v[72:75], v16 offset:55296
  v_mfma_f32_16x16x32_bf16 v[244:247], v[100:103], v[80:83], v[244:247]
  v_mfma_f32_16x16x32_bf16 v[220:223], v[104:107], v[76:79], v[220:223]
  v_mfma_f32_16x16x32_bf16 v[248:251], v[104:107], v[80:83], v[248:251]
  v_mfma_f32_16x16x32_bf16 v[224:227], v[108:111], v[76:79], v[224:227]
  v_mfma_f32_16x16x32_bf16 v[252:255], v[108:111], v[80:83], v[252:255]
  s_waitcnt lgkmcnt(0)
  v_mfma_f32_16x16x32_bf16 v[200:203], v[48:51], v[40:43], v[200:203]
  ds_read_b128 v[76:79], v13 offset:32768
  v_mfma_f32_16x16x32_bf16 v[228:231], v[48:51], v[44:47], v[228:231]
  ds_read_b128 v[80:83], v13 offset:34816
  v_mfma_f32_16x16x32_bf16 v[204:207], v[52:55], v[40:43], v[204:207]
  ds_read_b128 v[84:87], v16 offset:56320
  v_mfma_f32_16x16x32_bf16 v[232:235], v[52:55], v[44:47], v[232:235]
  ds_read_b128 v[88:91], v16 offset:57344
  v_mfma_f32_16x16x32_bf16 v[208:211], v[56:59], v[40:43], v[208:211]
  ds_read_b128 v[92:95], v16 offset:58368
  v_mfma_f32_16x16x32_bf16 v[236:239], v[56:59], v[44:47], v[236:239]
  ds_read_b128 v[96:99], v16 offset:59392
  v_mfma_f32_16x16x32_bf16 v[212:215], v[60:63], v[40:43], v[212:215]
  ds_read_b128 v[100:103], v16 offset:60416
  v_mfma_f32_16x16x32_bf16 v[240:243], v[60:63], v[44:47], v[240:243]
  ds_read_b128 v[104:107], v16 offset:61440
  v_mfma_f32_16x16x32_bf16 v[216:219], v[64:67], v[40:43], v[216:219]
  ds_read_b128 v[108:111], v16 offset:62464
  v_mfma_f32_16x16x32_bf16 v[244:247], v[64:67], v[44:47], v[244:247]
  v_mfma_f32_16x16x32_bf16 v[220:223], v[68:71], v[40:43], v[220:223]
  v_mfma_f32_16x16x32_bf16 v[248:251], v[68:71], v[44:47], v[248:251]
  v_mfma_f32_16x16x32_bf16 v[224:227], v[72:75], v[40:43], v[224:227]
  v_mfma_f32_16x16x32_bf16 v[252:255], v[72:75], v[44:47], v[252:255]
  s_waitcnt lgkmcnt(0)
  s_barrier
  v_mfma_f32_16x16x32_bf16 v[200:203], v[84:87], v[76:79], v[200:203]
  ds_read_b128 v[40:43], v11 offset:0
  v_mfma_f32_16x16x32_bf16 v[228:231], v[84:87], v[80:83], v[228:231]
  ds_read_b128 v[44:47], v11 offset:2048
  v_mfma_f32_16x16x32_bf16 v[204:207], v[88:91], v[76:79], v[204:207]
  ds_read_b128 v[48:51], v17 offset:16384
  v_mfma_f32_16x16x32_bf16 v[232:235], v[88:91], v[80:83], v[232:235]
  ds_read_b128 v[52:55], v17 offset:17408
  v_mfma_f32_16x16x32_bf16 v[208:211], v[92:95], v[76:79], v[208:211]
  ds_read_b128 v[56:59], v17 offset:18432
  v_mfma_f32_16x16x32_bf16 v[236:239], v[92:95], v[80:83], v[236:239]
  ds_read_b128 v[60:63], v17 offset:19456
  v_mfma_f32_16x16x32_bf16 v[212:215], v[96:99], v[76:79], v[212:215]
  ds_read_b128 v[64:67], v17 offset:20480
  v_mfma_f32_16x16x32_bf16 v[240:243], v[96:99], v[80:83], v[240:243]
  ds_read_b128 v[68:71], v17 offset:21504
  v_mfma_f32_16x16x32_bf16 v[216:219], v[100:103], v[76:79], v[216:219]
  ds_read_b128 v[72:75], v17 offset:22528
  v_mfma_f32_16x16x32_bf16 v[244:247], v[100:103], v[80:83], v[244:247]
  v_mfma_f32_16x16x32_bf16 v[220:223], v[104:107], v[76:79], v[220:223]
  v_mfma_f32_16x16x32_bf16 v[248:251], v[104:107], v[80:83], v[248:251]
  v_mfma_f32_16x16x32_bf16 v[224:227], v[108:111], v[76:79], v[224:227]
  v_mfma_f32_16x16x32_bf16 v[252:255], v[108:111], v[80:83], v[252:255]
  s_waitcnt lgkmcnt(0)
  v_mfma_f32_16x16x32_bf16 v[200:203], v[48:51], v[40:43], v[200:203]
  ds_read_b128 v[76:79], v14 offset:0
  v_mfma_f32_16x16x32_bf16 v[228:231], v[48:51], v[44:47], v[228:231]
  ds_read_b128 v[80:83], v14 offset:2048
  v_mfma_f32_16x16x32_bf16 v[204:207], v[52:55], v[40:43], v[204:207]
  ds_read_b128 v[84:87], v17 offset:23552
  v_mfma_f32_16x16x32_bf16 v[232:235], v[52:55], v[44:47], v[232:235]
  ds_read_b128 v[88:91], v17 offset:24576
  v_mfma_f32_16x16x32_bf16 v[208:211], v[56:59], v[40:43], v[208:211]
  ds_read_b128 v[92:95], v17 offset:25600
  v_mfma_f32_16x16x32_bf16 v[236:239], v[56:59], v[44:47], v[236:239]
  ds_read_b128 v[96:99], v17 offset:26624
  v_mfma_f32_16x16x32_bf16 v[212:215], v[60:63], v[40:43], v[212:215]
  ds_read_b128 v[100:103], v17 offset:27648
  v_mfma_f32_16x16x32_bf16 v[240:243], v[60:63], v[44:47], v[240:243]
  ds_read_b128 v[104:107], v17 offset:28672
  v_mfma_f32_16x16x32_bf16 v[216:219], v[64:67], v[40:43], v[216:219]
  ds_read_b128 v[108:111], v17 offset:29696
  v_mfma_f32_16x16x32_bf16 v[244:247], v[64:67], v[44:47], v[244:247]
  v_mfma_f32_16x16x32_bf16 v[220:223], v[68:71], v[40:43], v[220:223]
  v_mfma_f32_16x16x32_bf16 v[248:251], v[68:71], v[44:47], v[248:251]
  v_mfma_f32_16x16x32_bf16 v[224:227], v[72:75], v[40:43], v[224:227]
  v_mfma_f32_16x16x32_bf16 v[252:255], v[72:75], v[44:47], v[252:255]
  s_waitcnt lgkmcnt(0)
  s_barrier
  v_mfma_f32_16x16x32_bf16 v[200:203], v[84:87], v[76:79], v[200:203]
  ds_read_b128 v[40:43], v11 offset:32768
  v_mfma_f32_16x16x32_bf16 v[228:231], v[84:87], v[80:83], v[228:231]
  ds_read_b128 v[44:47], v11 offset:34816
  v_mfma_f32_16x16x32_bf16 v[204:207], v[88:91], v[76:79], v[204:207]
  ds_read_b128 v[48:51], v17 offset:49152
  v_mfma_f32_16x16x32_bf16 v[232:235], v[88:91], v[80:83], v[232:235]
  ds_read_b128 v[52:55], v17 offset:50176
  v_mfma_f32_16x16x32_bf16 v[208:211], v[92:95], v[76:79], v[208:211]
  ds_read_b128 v[56:59], v17 offset:51200
  v_mfma_f32_16x16x32_bf16 v[236:239], v[92:95], v[80:83], v[236:239]
  ds_read_b128 v[60:63], v17 offset:52224
  v_mfma_f32_16x16x32_bf16 v[212:215], v[96:99], v[76:79], v[212:215]
  ds_read_b128 v[64:67], v17 offset:53248
  v_mfma_f32_16x16x32_bf16 v[240:243], v[96:99], v[80:83], v[240:243]
  ds_read_b128 v[68:71], v17 offset:54272
  v_mfma_f32_16x16x32_bf16 v[216:219], v[100:103], v[76:79], v[216:219]
  ds_read_b128 v[72:75], v17 offset:55296
  v_mfma_f32_16x16x32_bf16 v[244:247], v[100:103], v[80:83], v[244:247]
  v_mfma_f32_16x16x32_bf16 v[220:223], v[104:107], v[76:79], v[220:223]
  v_mfma_f32_16x16x32_bf16 v[248:251], v[104:107], v[80:83], v[248:251]
  v_mfma_f32_16x16x32_bf16 v[224:227], v[108:111], v[76:79], v[224:227]
  v_mfma_f32_16x16x32_bf16 v[252:255], v[108:111], v[80:83], v[252:255]
  s_waitcnt lgkmcnt(0)
  v_mfma_f32_16x16x32_bf16 v[200:203], v[48:51], v[40:43], v[200:203]
  ds_read_b128 v[76:79], v14 offset:32768
  v_mfma_f32_16x16x32_bf16 v[228:231], v[48:51], v[44:47], v[228:231]
  ds_read_b128 v[80:83], v14 offset:34816
  v_mfma_f32_16x16x32_bf16 v[204:207], v[52:55], v[40:43], v[204:207]
  ds_read_b128 v[84:87], v17 offset:56320
  v_mfma_f32_16x16x32_bf16 v[232:235], v[52:55], v[44:47], v[232:235]
  ds_read_b128 v[88:91], v17 offset:57344
  v_mfma_f32_16x16x32_bf16 v[208:211], v[56:59], v[40:43], v[208:211]
  ds_read_b128 v[92:95], v17 offset:58368
  v_mfma_f32_16x16x32_bf16 v[236:239], v[56:59], v[44:47], v[236:239]
  ds_read_b128 v[96:99], v17 offset:59392
  v_mfma_f32_16x16x32_bf16 v[212:215], v[60:63], v[40:43], v[212:215]
  ds_read_b128 v[100:103], v17 offset:60416
  v_mfma_f32_16x16x32_bf16 v[240:243], v[60:63], v[44:47], v[240:243]
  ds_read_b128 v[104:107], v17 offset:61440
  v_mfma_f32_16x16x32_bf16 v[216:219], v[64:67], v[40:43], v[216:219]
  ds_read_b128 v[108:111], v17 offset:62464
  v_mfma_f32_16x16x32_bf16 v[244:247], v[64:67], v[44:47], v[244:247]
  v_mfma_f32_16x16x32_bf16 v[220:223], v[68:71], v[40:43], v[220:223]
  v_mfma_f32_16x16x32_bf16 v[248:251], v[68:71], v[44:47], v[248:251]
  v_mfma_f32_16x16x32_bf16 v[224:227], v[72:75], v[40:43], v[224:227]
  v_mfma_f32_16x16x32_bf16 v[252:255], v[72:75], v[44:47], v[252:255]
  s_waitcnt lgkmcnt(0)
  s_barrier
  v_mfma_f32_16x16x32_bf16 v[200:203], v[84:87], v[76:79], v[200:203]
  ds_read_b128 v[40:43], v10 offset:0
  v_mfma_f32_16x16x32_bf16 v[228:231], v[84:87], v[80:83], v[228:231]
  ds_read_b128 v[44:47], v10 offset:2048
  v_mfma_f32_16x16x32_bf16 v[204:207], v[88:91], v[76:79], v[204:207]
  ds_read_b128 v[48:51], v18 offset:0
  v_mfma_f32_16x16x32_bf16 v[232:235], v[88:91], v[80:83], v[232:235]
  ds_read_b128 v[52:55], v18 offset:1024
  v_mfma_f32_16x16x32_bf16 v[208:211], v[92:95], v[76:79], v[208:211]
  ds_read_b128 v[56:59], v18 offset:2048
  v_mfma_f32_16x16x32_bf16 v[236:239], v[92:95], v[80:83], v[236:239]
  ds_read_b128 v[60:63], v18 offset:3072
  v_mfma_f32_16x16x32_bf16 v[212:215], v[96:99], v[76:79], v[212:215]
  ds_read_b128 v[64:67], v18 offset:4096
  v_mfma_f32_16x16x32_bf16 v[240:243], v[96:99], v[80:83], v[240:243]
  ds_read_b128 v[68:71], v18 offset:5120
  v_mfma_f32_16x16x32_bf16 v[216:219], v[100:103], v[76:79], v[216:219]
  ds_read_b128 v[72:75], v18 offset:6144
  v_mfma_f32_16x16x32_bf16 v[244:247], v[100:103], v[80:83], v[244:247]
  v_mfma_f32_16x16x32_bf16 v[220:223], v[104:107], v[76:79], v[220:223]
  v_mfma_f32_16x16x32_bf16 v[248:251], v[104:107], v[80:83], v[248:251]
  v_mfma_f32_16x16x32_bf16 v[224:227], v[108:111], v[76:79], v[224:227]
  v_mfma_f32_16x16x32_bf16 v[252:255], v[108:111], v[80:83], v[252:255]
  s_waitcnt lgkmcnt(0)
  v_mfma_f32_16x16x32_bf16 v[200:203], v[48:51], v[40:43], v[200:203]
  ds_read_b128 v[76:79], v13 offset:0
  v_mfma_f32_16x16x32_bf16 v[228:231], v[48:51], v[44:47], v[228:231]
  ds_read_b128 v[80:83], v13 offset:2048
  v_mfma_f32_16x16x32_bf16 v[204:207], v[52:55], v[40:43], v[204:207]
  ds_read_b128 v[84:87], v18 offset:7168
  v_mfma_f32_16x16x32_bf16 v[232:235], v[52:55], v[44:47], v[232:235]
  ds_read_b128 v[88:91], v18 offset:8192
  v_mfma_f32_16x16x32_bf16 v[208:211], v[56:59], v[40:43], v[208:211]
  ds_read_b128 v[92:95], v18 offset:9216
  v_mfma_f32_16x16x32_bf16 v[236:239], v[56:59], v[44:47], v[236:239]
  ds_read_b128 v[96:99], v18 offset:10240
  v_mfma_f32_16x16x32_bf16 v[212:215], v[60:63], v[40:43], v[212:215]
  ds_read_b128 v[100:103], v18 offset:11264
  v_mfma_f32_16x16x32_bf16 v[240:243], v[60:63], v[44:47], v[240:243]
  ds_read_b128 v[104:107], v18 offset:12288
  v_mfma_f32_16x16x32_bf16 v[216:219], v[64:67], v[40:43], v[216:219]
  ds_read_b128 v[108:111], v18 offset:13312
  v_mfma_f32_16x16x32_bf16 v[244:247], v[64:67], v[44:47], v[244:247]
  v_mfma_f32_16x16x32_bf16 v[220:223], v[68:71], v[40:43], v[220:223]
  v_mfma_f32_16x16x32_bf16 v[248:251], v[68:71], v[44:47], v[248:251]
  v_mfma_f32_16x16x32_bf16 v[224:227], v[72:75], v[40:43], v[224:227]
  v_mfma_f32_16x16x32_bf16 v[252:255], v[72:75], v[44:47], v[252:255]
  s_waitcnt lgkmcnt(0)
  s_barrier
  v_mfma_f32_16x16x32_bf16 v[200:203], v[84:87], v[76:79], v[200:203]
  ds_read_b128 v[40:43], v10 offset:16384
  v_mfma_f32_16x16x32_bf16 v[228:231], v[84:87], v[80:83], v[228:231]
  ds_read_b128 v[44:47], v10 offset:18432
  v_mfma_f32_16x16x32_bf16 v[204:207], v[88:91], v[76:79], v[204:207]
  ds_read_b128 v[48:51], v18 offset:16384
  v_mfma_f32_16x16x32_bf16 v[232:235], v[88:91], v[80:83], v[232:235]
  ds_read_b128 v[52:55], v18 offset:17408
  v_mfma_f32_16x16x32_bf16 v[208:211], v[92:95], v[76:79], v[208:211]
  ds_read_b128 v[56:59], v18 offset:18432
  v_mfma_f32_16x16x32_bf16 v[236:239], v[92:95], v[80:83], v[236:239]
  ds_read_b128 v[60:63], v18 offset:19456
  v_mfma_f32_16x16x32_bf16 v[212:215], v[96:99], v[76:79], v[212:215]
  ds_read_b128 v[64:67], v18 offset:20480
  v_mfma_f32_16x16x32_bf16 v[240:243], v[96:99], v[80:83], v[240:243]
  ds_read_b128 v[68:71], v18 offset:21504
  v_mfma_f32_16x16x32_bf16 v[216:219], v[100:103], v[76:79], v[216:219]
  ds_read_b128 v[72:75], v18 offset:22528
  v_mfma_f32_16x16x32_bf16 v[244:247], v[100:103], v[80:83], v[244:247]
  v_mfma_f32_16x16x32_bf16 v[220:223], v[104:107], v[76:79], v[220:223]
  v_mfma_f32_16x16x32_bf16 v[248:251], v[104:107], v[80:83], v[248:251]
  v_mfma_f32_16x16x32_bf16 v[224:227], v[108:111], v[76:79], v[224:227]
  v_mfma_f32_16x16x32_bf16 v[252:255], v[108:111], v[80:83], v[252:255]
  s_waitcnt lgkmcnt(0)
  v_mfma_f32_16x16x32_bf16 v[200:203], v[48:51], v[40:43], v[200:203]
  ds_read_b128 v[76:79], v13 offset:16384
  v_mfma_f32_16x16x32_bf16 v[228:231], v[48:51], v[44:47], v[228:231]
  ds_read_b128 v[80:83], v13 offset:18432
  v_mfma_f32_16x16x32_bf16 v[204:207], v[52:55], v[40:43], v[204:207]
  ds_read_b128 v[84:87], v18 offset:23552
  v_mfma_f32_16x16x32_bf16 v[232:235], v[52:55], v[44:47], v[232:235]
  ds_read_b128 v[88:91], v18 offset:24576
  v_mfma_f32_16x16x32_bf16 v[208:211], v[56:59], v[40:43], v[208:211]
  ds_read_b128 v[92:95], v18 offset:25600
  v_mfma_f32_16x16x32_bf16 v[236:239], v[56:59], v[44:47], v[236:239]
  ds_read_b128 v[96:99], v18 offset:26624
  v_mfma_f32_16x16x32_bf16 v[212:215], v[60:63], v[40:43], v[212:215]
  ds_read_b128 v[100:103], v18 offset:27648
  v_mfma_f32_16x16x32_bf16 v[240:243], v[60:63], v[44:47], v[240:243]
  ds_read_b128 v[104:107], v18 offset:28672
  v_mfma_f32_16x16x32_bf16 v[216:219], v[64:67], v[40:43], v[216:219]
  ds_read_b128 v[108:111], v18 offset:29696
  v_mfma_f32_16x16x32_bf16 v[244:247], v[64:67], v[44:47], v[244:247]
  v_mfma_f32_16x16x32_bf16 v[220:223], v[68:71], v[40:43], v[220:223]
  v_mfma_f32_16x16x32_bf16 v[248:251], v[68:71], v[44:47], v[248:251]
  v_mfma_f32_16x16x32_bf16 v[224:227], v[72:75], v[40:43], v[224:227]
  v_mfma_f32_16x16x32_bf16 v[252:255], v[72:75], v[44:47], v[252:255]
  s_waitcnt lgkmcnt(0)
  s_barrier
  v_mfma_f32_16x16x32_bf16 v[200:203], v[84:87], v[76:79], v[200:203]
  ds_read_b128 v[40:43], v10 offset:32768
  v_mfma_f32_16x16x32_bf16 v[228:231], v[84:87], v[80:83], v[228:231]
  ds_read_b128 v[44:47], v10 offset:34816
  v_mfma_f32_16x16x32_bf16 v[204:207], v[88:91], v[76:79], v[204:207]
  ds_read_b128 v[48:51], v16 offset:49152
  v_mfma_f32_16x16x32_bf16 v[232:235], v[88:91], v[80:83], v[232:235]
  ds_read_b128 v[52:55], v16 offset:50176
  v_mfma_f32_16x16x32_bf16 v[208:211], v[92:95], v[76:79], v[208:211]
  ds_read_b128 v[56:59], v16 offset:51200
  v_mfma_f32_16x16x32_bf16 v[236:239], v[92:95], v[80:83], v[236:239]
  ds_read_b128 v[60:63], v16 offset:52224
  v_mfma_f32_16x16x32_bf16 v[212:215], v[96:99], v[76:79], v[212:215]
  ds_read_b128 v[64:67], v16 offset:53248
  v_mfma_f32_16x16x32_bf16 v[240:243], v[96:99], v[80:83], v[240:243]
  ds_read_b128 v[68:71], v16 offset:54272
  v_mfma_f32_16x16x32_bf16 v[216:219], v[100:103], v[76:79], v[216:219]
  ds_read_b128 v[72:75], v16 offset:55296
  v_mfma_f32_16x16x32_bf16 v[244:247], v[100:103], v[80:83], v[244:247]
  v_mfma_f32_16x16x32_bf16 v[220:223], v[104:107], v[76:79], v[220:223]
  v_mfma_f32_16x16x32_bf16 v[248:251], v[104:107], v[80:83], v[248:251]
  v_mfma_f32_16x16x32_bf16 v[224:227], v[108:111], v[76:79], v[224:227]
  v_mfma_f32_16x16x32_bf16 v[252:255], v[108:111], v[80:83], v[252:255]
  s_waitcnt lgkmcnt(0)
  v_mfma_f32_16x16x32_bf16 v[200:203], v[48:51], v[40:43], v[200:203]
  ds_read_b128 v[76:79], v13 offset:32768
  v_mfma_f32_16x16x32_bf16 v[228:231], v[48:51], v[44:47], v[228:231]
  ds_read_b128 v[80:83], v13 offset:34816
  v_mfma_f32_16x16x32_bf16 v[204:207], v[52:55], v[40:43], v[204:207]
  ds_read_b128 v[84:87], v16 offset:56320
  v_mfma_f32_16x16x32_bf16 v[232:235], v[52:55], v[44:47], v[232:235]
  ds_read_b128 v[88:91], v16 offset:57344
  v_mfma_f32_16x16x32_bf16 v[208:211], v[56:59], v[40:43], v[208:211]
  ds_read_b128 v[92:95], v16 offset:58368
  v_mfma_f32_16x16x32_bf16 v[236:239], v[56:59], v[44:47], v[236:239]
  ds_read_b128 v[96:99], v16 offset:59392
  v_mfma_f32_16x16x32_bf16 v[212:215], v[60:63], v[40:43], v[212:215]
  ds_read_b128 v[100:103], v16 offset:60416
  v_mfma_f32_16x16x32_bf16 v[240:243], v[60:63], v[44:47], v[240:243]
  ds_read_b128 v[104:107], v16 offset:61440
  v_mfma_f32_16x16x32_bf16 v[216:219], v[64:67], v[40:43], v[216:219]
  ds_read_b128 v[108:111], v16 offset:62464
  v_mfma_f32_16x16x32_bf16 v[244:247], v[64:67], v[44:47], v[244:247]
  v_mfma_f32_16x16x32_bf16 v[220:223], v[68:71], v[40:43], v[220:223]
  v_mfma_f32_16x16x32_bf16 v[248:251], v[68:71], v[44:47], v[248:251]
  v_mfma_f32_16x16x32_bf16 v[224:227], v[72:75], v[40:43], v[224:227]
  v_mfma_f32_16x16x32_bf16 v[252:255], v[72:75], v[44:47], v[252:255]
  s_waitcnt lgkmcnt(0)
  s_barrier
  v_mfma_f32_16x16x32_bf16 v[200:203], v[84:87], v[76:79], v[200:203]
  v_mfma_f32_16x16x32_bf16 v[228:231], v[84:87], v[80:83], v[228:231]
  v_mfma_f32_16x16x32_bf16 v[204:207], v[88:91], v[76:79], v[204:207]
  v_mfma_f32_16x16x32_bf16 v[232:235], v[88:91], v[80:83], v[232:235]
  v_mfma_f32_16x16x32_bf16 v[208:211], v[92:95], v[76:79], v[208:211]
  v_mfma_f32_16x16x32_bf16 v[236:239], v[92:95], v[80:83], v[236:239]
  v_mfma_f32_16x16x32_bf16 v[212:215], v[96:99], v[76:79], v[212:215]
  v_mfma_f32_16x16x32_bf16 v[240:243], v[96:99], v[80:83], v[240:243]
  v_mfma_f32_16x16x32_bf16 v[216:219], v[100:103], v[76:79], v[216:219]
  v_mfma_f32_16x16x32_bf16 v[244:247], v[100:103], v[80:83], v[244:247]
  v_mfma_f32_16x16x32_bf16 v[220:223], v[104:107], v[76:79], v[220:223]
  v_mfma_f32_16x16x32_bf16 v[248:251], v[104:107], v[80:83], v[248:251]
  v_mfma_f32_16x16x32_bf16 v[224:227], v[108:111], v[76:79], v[224:227]
  v_mfma_f32_16x16x32_bf16 v[252:255], v[108:111], v[80:83], v[252:255]
  s_lshr_b32 s70, s65, 1
  s_cmp_eq_u32 s70, s64
  s_cbranch_scc1 L_own_29
  v_cvt_pk_bf16_f32 v200, v200, v201
  v_cvt_pk_bf16_f32 v201, v202, v203
  v_cvt_pk_bf16_f32 v202, v204, v205
  v_cvt_pk_bf16_f32 v203, v206, v207
  buffer_store_dwordx4 v[200:203], v5, s[52:55], s76 offen offset:0 sc1
  v_cvt_pk_bf16_f32 v228, v228, v229
  v_cvt_pk_bf16_f32 v229, v230, v231
  v_cvt_pk_bf16_f32 v230, v232, v233
  v_cvt_pk_bf16_f32 v231, v234, v235
  buffer_store_dwordx4 v[228:231], v5, s[52:55], s76 offen offset:3072 sc1
  v_cvt_pk_bf16_f32 v208, v208, v209
  v_cvt_pk_bf16_f32 v209, v210, v211
  v_cvt_pk_bf16_f32 v210, v212, v213
  v_cvt_pk_bf16_f32 v211, v214, v215
  buffer_store_dwordx4 v[208:211], v5, s[52:55], s76 offen offset:1024 sc1
  v_cvt_pk_bf16_f32 v236, v236, v237
  v_cvt_pk_bf16_f32 v237, v238, v239
  v_cvt_pk_bf16_f32 v238, v240, v241
  v_cvt_pk_bf16_f32 v239, v242, v243
  buffer_store_dwordx4 v[236:239], v5, s[52:55], s77 offen offset:0 sc1
  v_cvt_pk_bf16_f32 v216, v216, v217
  v_cvt_pk_bf16_f32 v217, v218, v219
  v_cvt_pk_bf16_f32 v218, v220, v221
  v_cvt_pk_bf16_f32 v219, v222, v223
  buffer_store_dwordx4 v[216:219], v5, s[52:55], s76 offen offset:2048 sc1
  v_cvt_pk_bf16_f32 v244, v244, v245
  v_cvt_pk_bf16_f32 v245, v246, v247
  v_cvt_pk_bf16_f32 v246, v248, v249
  v_cvt_pk_bf16_f32 v247, v250, v251
  buffer_store_dwordx4 v[244:247], v5, s[52:55], s77 offen offset:1024 sc1
  v_cvt_pk_bf16_f32 v224, v224, v225
  v_cvt_pk_bf16_f32 v225, v226, v227
  v_cvt_pk_bf16_f32 v226, v252, v253
  v_cvt_pk_bf16_f32 v227, v254, v255
  buffer_store_dwordx4 v[224:227], v5, s[52:55], s77 offen offset:2048 sc1
  s_branch L_pd_30
L_own_29:
  v_cvt_pk_bf16_f32 v200, v200, v201
  v_cvt_pk_bf16_f32 v201, v202, v203
  v_cvt_pk_bf16_f32 v202, v204, v205
  v_cvt_pk_bf16_f32 v203, v206, v207
  ds_write_b128 v17, v[200:203] offset:14336
  v_cvt_pk_bf16_f32 v228, v228, v229
  v_cvt_pk_bf16_f32 v229, v230, v231
  v_cvt_pk_bf16_f32 v230, v232, v233
  v_cvt_pk_bf16_f32 v231, v234, v235
  ds_write_b128 v17, v[228:231] offset:63488
  v_cvt_pk_bf16_f32 v208, v208, v209
  v_cvt_pk_bf16_f32 v209, v210, v211
  v_cvt_pk_bf16_f32 v210, v212, v213
  v_cvt_pk_bf16_f32 v211, v214, v215
  ds_write_b128 v17, v[208:211] offset:30720
  v_cvt_pk_bf16_f32 v236, v236, v237
  v_cvt_pk_bf16_f32 v237, v238, v239
  v_cvt_pk_bf16_f32 v238, v240, v241
  v_cvt_pk_bf16_f32 v239, v242, v243
  ds_write_b128 v17, v[236:239] offset:15360
  v_cvt_pk_bf16_f32 v216, v216, v217
  v_cvt_pk_bf16_f32 v217, v218, v219
  v_cvt_pk_bf16_f32 v218, v220, v221
  v_cvt_pk_bf16_f32 v219, v222, v223
  ds_write_b128 v17, v[216:219] offset:47104
  v_cvt_pk_bf16_f32 v244, v244, v245
  v_cvt_pk_bf16_f32 v245, v246, v247
  v_cvt_pk_bf16_f32 v246, v248, v249
  v_cvt_pk_bf16_f32 v247, v250, v251
  ds_write_b128 v17, v[244:247] offset:31744
  v_cvt_pk_bf16_f32 v224, v224, v225
  v_cvt_pk_bf16_f32 v225, v226, v227
  v_cvt_pk_bf16_f32 v226, v252, v253
  v_cvt_pk_bf16_f32 v227, v254, v255
  ds_write_b128 v17, v[224:227] offset:48128
  s_waitcnt lgkmcnt(0)
L_pd_30:
  v_lshrrev_b32 v4, 2, v3
  v_lshl_add_u32 v4, v2, 2, v4
  v_and_b32 v7, 6, v4
  v_bfe_u32 v6, v3, 1, 1
  v_or_b32 v7, v7, v6
  s_and_b32 s70, s64, 1
  s_lshl_b32 s70, s70, 2
  v_xor_b32 v7, s70, v7
  v_lshlrev_b32 v4, 7, v4
  v_lshl_add_u32 v4, v7, 4, v4
  v_and_b32 v6, 1, v3
  v_lshl_add_u32 v8, v6, 3, v4
  v_xor_b32 v11, 32, v8
  v_cmp_eq_u32 vcc, 3, v2
  v_add_u32 v14, 2048, v8
  v_add_u32 v17, 2048, v11
  v_cndmask_b32 v14, v14, v8, vcc
  v_cndmask_b32 v17, v17, v11, vcc
  v_add_u32 v9, 0x10000, v8
  v_add_u32 v10, 0x20000, v8
  v_add_u32 v12, 0x10000, v11
  v_add_u32 v13, 0x20000, v11
  v_add_u32 v15, 0x10000, v14
  v_add_u32 v16, 0x20000, v14
  v_add_u32 v18, 0x10000, v17
  v_add_u32 v19, 0x20000, v17
  s_lshr_b32 s70, s64, 1
  s_lshl_b32 s70, s70, 13
  v_add_u32 v32, s70, v5
  v_add_u32 v33, 0x10000, v32
  v_add_u32 v34, 0x20000, v32
  v_mul_u32_u24 v20, 1792, v3
  v_lshl_add_u32 v20, v2, 3, v20
  s_and_b32 s70, s66, 3
  s_lshl_b32 s71, s65, 2
  s_add_u32 s70, s70, s71
  s_lshl_b32 s70, s70, 1
  s_lshr_b32 s71, s64, 1
  s_add_u32 s70, s70, s71
  s_mul_i32 s80, s70, 57344
  s_lshr_b32 s70, s66, 2
  s_min_u32 s70, s70, 6
  s_lshl_b32 s70, s70, 1
  s_and_b32 s71, s64, 1
  s_add_u32 s70, s70, s71
  s_lshl_b32 s70, s70, 6
  s_add_u32 s80, s80, s70
  s_add_u32 s81, s80, 28672
  s_waitcnt vmcnt(0)
  s_add_u32 s70, s26, 98304
  v_mov_b32 v36, s68
  s_mov_b64 exec, 1
  buffer_store_dword v36, v37, s[52:55], s70 offen sc1
  s_mov_b64 exec, -1
  s_barrier
  s_cmp_ge_u32 s66, 28
  s_cbranch_scc1 L_end_1
  ds_read_b64_tr_b16 v[48:49], v9 offset:0
  ds_read_b64_tr_b16 v[50:51], v15 offset:0
  ds_read_b64_tr_b16 v[52:53], v12 offset:0
  ds_read_b64_tr_b16 v[54:55], v18 offset:0
  ds_read_b128 v[56:59], v32 offset:0
  ds_read_b128 v[60:63], v32 offset:4096
  ds_read_b64_tr_b16 v[64:65], v9 offset:3584
  ds_read_b64_tr_b16 v[66:67], v15 offset:3584
  ds_read_b64_tr_b16 v[68:69], v12 offset:3584
  ds_read_b64_tr_b16 v[70:71], v18 offset:3584
  ds_read_b128 v[72:75], v32 offset:1024
  ds_read_b128 v[76:79], v32 offset:5120
  s_waitcnt lgkmcnt(0)
  v_mfma_f32_16x16x32_bf16 v[112:115], v[48:51], v[56:59], 0
  ds_read_b64_tr_b16 v[80:81], v9 offset:7168
  ds_read_b64_tr_b16 v[82:83], v15 offset:7168
  v_mfma_f32_16x16x32_bf16 v[120:123], v[48:51], v[60:63], 0
  ds_read_b64_tr_b16 v[84:85], v12 offset:7168
  ds_read_b64_tr_b16 v[86:87], v18 offset:7168
  v_mfma_f32_16x16x32_bf16 v[116:119], v[52:55], v[56:59], 0
  ds_read_b128 v[88:91], v32 offset:2048
  ds_read_b128 v[92:95], v32 offset:6144
  v_mfma_f32_16x16x32_bf16 v[124:127], v[52:55], v[60:63], 0
  ds_read_b64_tr_b16 v[96:97], v9 offset:10752
  ds_read_b64_tr_b16 v[98:99], v15 offset:10752
  v_mfma_f32_16x16x32_bf16 v[112:115], v[64:67], v[72:75], v[112:115]
  ds_read_b64_tr_b16 v[100:101], v12 offset:10752
  ds_read_b64_tr_b16 v[102:103], v18 offset:10752
  v_mfma_f32_16x16x32_bf16 v[120:123], v[64:67], v[76:79], v[120:123]
  ds_read_b128 v[104:107], v32 offset:3072
  ds_read_b128 v[108:111], v32 offset:7168
  v_mfma_f32_16x16x32_bf16 v[116:119], v[68:71], v[72:75], v[116:119]
  v_mfma_f32_16x16x32_bf16 v[124:127], v[68:71], v[76:79], v[124:127]
  s_waitcnt lgkmcnt(0)
  v_mfma_f32_16x16x32_bf16 v[112:115], v[80:83], v[88:91], v[112:115]
  ds_read_b64_tr_b16 v[48:49], v9 offset:16384
  ds_read_b64_tr_b16 v[50:51], v15 offset:16384
  v_mfma_f32_16x16x32_bf16 v[120:123], v[80:83], v[92:95], v[120:123]
  ds_read_b64_tr_b16 v[52:53], v12 offset:16384
  ds_read_b64_tr_b16 v[54:55], v18 offset:16384
  v_mfma_f32_16x16x32_bf16 v[116:119], v[84:87], v[88:91], v[116:119]
  ds_read_b128 v[56:59], v34 offset:0
  ds_read_b128 v[60:63], v34 offset:4096
  v_mfma_f32_16x16x32_bf16 v[124:127], v[84:87], v[92:95], v[124:127]
  ds_read_b64_tr_b16 v[64:65], v9 offset:19968
  ds_read_b64_tr_b16 v[66:67], v15 offset:19968
  v_mfma_f32_16x16x32_bf16 v[112:115], v[96:99], v[104:107], v[112:115]
  ds_read_b64_tr_b16 v[68:69], v12 offset:19968
  ds_read_b64_tr_b16 v[70:71], v18 offset:19968
  v_mfma_f32_16x16x32_bf16 v[120:123], v[96:99], v[108:111], v[120:123]
  ds_read_b128 v[72:75], v34 offset:1024
  ds_read_b128 v[76:79], v34 offset:5120
  v_mfma_f32_16x16x32_bf16 v[116:119], v[100:103], v[104:107], v[116:119]
  v_mfma_f32_16x16x32_bf16 v[124:127], v[100:103], v[108:111], v[124:127]
  s_waitcnt lgkmcnt(0)
  v_mfma_f32_16x16x32_bf16 v[112:115], v[48:51], v[56:59], v[112:115]
  ds_read_b64_tr_b16 v[80:81], v9 offset:23552
  ds_read_b64_tr_b16 v[82:83], v15 offset:23552
  v_mfma_f32_16x16x32_bf16 v[120:123], v[48:51], v[60:63], v[120:123]
  ds_read_b64_tr_b16 v[84:85], v12 offset:23552
  ds_read_b64_tr_b16 v[86:87], v18 offset:23552
  v_mfma_f32_16x16x32_bf16 v[116:119], v[52:55], v[56:59], v[116:119]
  ds_read_b128 v[88:91], v34 offset:2048
  ds_read_b128 v[92:95], v34 offset:6144
  v_mfma_f32_16x16x32_bf16 v[124:127], v[52:55], v[60:63], v[124:127]
  ds_read_b64_tr_b16 v[96:97], v9 offset:27136
  ds_read_b64_tr_b16 v[98:99], v15 offset:27136
  v_mfma_f32_16x16x32_bf16 v[112:115], v[64:67], v[72:75], v[112:115]
  ds_read_b64_tr_b16 v[100:101], v12 offset:27136
  ds_read_b64_tr_b16 v[102:103], v18 offset:27136
  v_mfma_f32_16x16x32_bf16 v[120:123], v[64:67], v[76:79], v[120:123]
  ds_read_b128 v[104:107], v34 offset:3072
  ds_read_b128 v[108:111], v34 offset:7168
  v_mfma_f32_16x16x32_bf16 v[116:119], v[68:71], v[72:75], v[116:119]
  v_mfma_f32_16x16x32_bf16 v[124:127], v[68:71], v[76:79], v[124:127]
  s_waitcnt lgkmcnt(0)
  v_mfma_f32_16x16x32_bf16 v[112:115], v[80:83], v[88:91], v[112:115]
  ds_read_b64_tr_b16 v[48:49], v9 offset:32768
  ds_read_b64_tr_b16 v[50:51], v15 offset:32768
  v_mfma_f32_16x16x32_bf16 v[120:123], v[80:83], v[92:95], v[120:123]
  ds_read_b64_tr_b16 v[52:53], v12 offset:32768
  ds_read_b64_tr_b16 v[54:55], v18 offset:32768
  v_mfma_f32_16x16x32_bf16 v[116:119], v[84:87], v[88:91], v[116:119]
  ds_read_b128 v[56:59], v32 offset:16384
  ds_read_b128 v[60:63], v32 offset:20480
  v_mfma_f32_16x16x32_bf16 v[124:127], v[84:87], v[92:95], v[124:127]
  ds_read_b64_tr_b16 v[64:65], v9 offset:36352
  ds_read_b64_tr_b16 v[66:67], v15 offset:36352
  v_mfma_f32_16x16x32_bf16 v[112:115], v[96:99], v[104:107], v[112:115]
  ds_read_b64_tr_b16 v[68:69], v12 offset:36352
  ds_read_b64_tr_b16 v[70:71], v18 offset:36352
  v_mfma_f32_16x16x32_bf16 v[120:123], v[96:99], v[108:111], v[120:123]
  ds_read_b128 v[72:75], v32 offset:17408
  ds_read_b128 v[76:79], v32 offset:21504
  v_mfma_f32_16x16x32_bf16 v[116:119], v[100:103], v[104:107], v[116:119]
  v_mfma_f32_16x16x32_bf16 v[124:127], v[100:103], v[108:111], v[124:127]
  s_waitcnt lgkmcnt(0)
  v_mfma_f32_16x16x32_bf16 v[112:115], v[48:51], v[56:59], v[112:115]
  ds_read_b64_tr_b16 v[80:81], v9 offset:39936
  ds_read_b64_tr_b16 v[82:83], v15 offset:39936
  v_mfma_f32_16x16x32_bf16 v[120:123], v[48:51], v[60:63], v[120:123]
  ds_read_b64_tr_b16 v[84:85], v12 offset:39936
  ds_read_b64_tr_b16 v[86:87], v18 offset:39936
  v_mfma_f32_16x16x32_bf16 v[116:119], v[52:55], v[56:59], v[116:119]
  ds_read_b128 v[88:91], v32 offset:18432
  ds_read_b128 v[92:95], v32 offset:22528
  v_mfma_f32_16x16x32_bf16 v[124:127], v[52:55], v[60:63], v[124:127]
  ds_read_b64_tr_b16 v[96:97], v9 offset:43520
  ds_read_b64_tr_b16 v[98:99], v15 offset:43520
  v_mfma_f32_16x16x32_bf16 v[112:115], v[64:67], v[72:75], v[112:115]
  ds_read_b64_tr_b16 v[100:101], v12 offset:43520
  ds_read_b64_tr_b16 v[102:103], v18 offset:43520
  v_mfma_f32_16x16x32_bf16 v[120:123], v[64:67], v[76:79], v[120:123]
  ds_read_b128 v[104:107], v32 offset:19456
  ds_read_b128 v[108:111], v32 offset:23552
  v_mfma_f32_16x16x32_bf16 v[116:119], v[68:71], v[72:75], v[116:119]
  v_mfma_f32_16x16x32_bf16 v[124:127], v[68:71], v[76:79], v[124:127]
  s_waitcnt lgkmcnt(0)
  v_mfma_f32_16x16x32_bf16 v[112:115], v[80:83], v[88:91], v[112:115]
  ds_read_b64_tr_b16 v[48:49], v9 offset:49152
  ds_read_b64_tr_b16 v[50:51], v15 offset:49152
  v_mfma_f32_16x16x32_bf16 v[120:123], v[80:83], v[92:95], v[120:123]
  ds_read_b64_tr_b16 v[52:53], v12 offset:49152
  ds_read_b64_tr_b16 v[54:55], v18 offset:49152
  v_mfma_f32_16x16x32_bf16 v[116:119], v[84:87], v[88:91], v[116:119]
  ds_read_b128 v[56:59], v34 offset:16384
  ds_read_b128 v[60:63], v34 offset:20480
  v_mfma_f32_16x16x32_bf16 v[124:127], v[84:87], v[92:95], v[124:127]
  ds_read_b64_tr_b16 v[64:65], v9 offset:52736
  ds_read_b64_tr_b16 v[66:67], v15 offset:52736
  v_mfma_f32_16x16x32_bf16 v[112:115], v[96:99], v[104:107], v[112:115]
  ds_read_b64_tr_b16 v[68:69], v12 offset:52736
  ds_read_b64_tr_b16 v[70:71], v18 offset:52736
  v_mfma_f32_16x16x32_bf16 v[120:123], v[96:99], v[108:111], v[120:123]
  ds_read_b128 v[72:75], v34 offset:17408
  ds_read_b128 v[76:79], v34 offset:21504
  v_mfma_f32_16x16x32_bf16 v[116:119], v[100:103], v[104:107], v[116:119]
  v_mfma_f32_16x16x32_bf16 v[124:127], v[100:103], v[108:111], v[124:127]
  s_waitcnt lgkmcnt(0)
  v_mfma_f32_16x16x32_bf16 v[112:115], v[48:51], v[56:59], v[112:115]
  ds_read_b64_tr_b16 v[80:81], v9 offset:56320
  ds_read_b64_tr_b16 v[82:83], v15 offset:56320
  v_mfma_f32_16x16x32_bf16 v[120:123], v[48:51], v[60:63], v[120:123]
  ds_read_b64_tr_b16 v[84:85], v12 offset:56320
  ds_read_b64_tr_b16 v[86:87], v18 offset:56320
  v_mfma_f32_16x16x32_bf16 v[116:119], v[52:55], v[56:59], v[116:119]
  ds_read_b128 v[88:91], v34 offset:18432
  ds_read_b128 v[92:95], v34 offset:22528
  v_mfma_f32_16x16x32_bf16 v[124:127], v[52:55], v[60:63], v[124:127]
  ds_read_b64_tr_b16 v[96:97], v9 offset:59904
  ds_read_b64_tr_b16 v[98:99], v15 offset:59904
  v_mfma_f32_16x16x32_bf16 v[112:115], v[64:67], v[72:75], v[112:115]
  ds_read_b64_tr_b16 v[100:101], v12 offset:59904
  ds_read_b64_tr_b16 v[102:103], v18 offset:59904
  v_mfma_f32_16x16x32_bf16 v[120:123], v[64:67], v[76:79], v[120:123]
  ds_read_b128 v[104:107], v34 offset:19456
  ds_read_b128 v[108:111], v34 offset:23552
  v_mfma_f32_16x16x32_bf16 v[116:119], v[68:71], v[72:75], v[116:119]
  v_mfma_f32_16x16x32_bf16 v[124:127], v[68:71], v[76:79], v[124:127]
  s_waitcnt lgkmcnt(0)
  v_mfma_f32_16x16x32_bf16 v[112:115], v[80:83], v[88:91], v[112:115]
  v_mfma_f32_16x16x32_bf16 v[120:123], v[80:83], v[92:95], v[120:123]
  v_mfma_f32_16x16x32_bf16 v[116:119], v[84:87], v[88:91], v[116:119]
  v_mfma_f32_16x16x32_bf16 v[124:127], v[84:87], v[92:95], v[124:127]
  v_mfma_f32_16x16x32_bf16 v[112:115], v[96:99], v[104:107], v[112:115]
  v_mfma_f32_16x16x32_bf16 v[120:123], v[96:99], v[108:111], v[120:123]
  v_mfma_f32_16x16x32_bf16 v[116:119], v[100:103], v[104:107], v[116:119]
  v_mfma_f32_16x16x32_bf16 v[124:127], v[100:103], v[108:111], v[124:127]
  s_nop 4
  v_cvt_pk_bf16_f32 v112, v112, v113
  v_cvt_pk_bf16_f32 v113, v114, v115
  v_cvt_pk_bf16_f32 v114, v116, v117
  v_cvt_pk_bf16_f32 v115, v118, v119
  buffer_store_dwordx2 v[112:113], v20, s[56:59], s80 offen
  buffer_store_dwordx2 v[114:115], v20, s[56:59], s80 offen offset:32
  v_cvt_pk_bf16_f32 v120, v120, v121
  v_cvt_pk_bf16_f32 v121, v122, v123
  v_cvt_pk_bf16_f32 v122, v124, v125
  v_cvt_pk_bf16_f32 v123, v126, v127
  buffer_store_dwordx2 v[120:121], v20, s[56:59], s81 offen
  buffer_store_dwordx2 v[122:123], v20, s[56:59], s81 offen offset:32
L_end_1:
  s_endpgm
.section .rodata,"a"
.p2align 6
.amdhsa_kernel concat_heads__sliding_block__spectral_fnet__prompt_kernel
  .amdhsa_next_free_vgpr 256
  .amdhsa_next_free_sgpr 102
  .amdhsa_accum_offset 256
  .amdhsa_group_segment_fixed_size 0
  .amdhsa_kernarg_size 88
  .amdhsa_user_sgpr_count 2
  .amdhsa_user_sgpr_kernarg_segment_ptr 1
  .amdhsa_system_sgpr_workgroup_id_x 1
.end_amdhsa_kernel
```
